```python
import torch

def _softmax(x, axis=-1):
    return torch.softmax(x, dim=axis)
def _gelu(x):
    return torch.nn.functional.gelu(x, approximate="tanh")
def _silu(x):
    return torch.nn.functional.silu(x)
def _sigmoid(x):
    return torch.sigmoid(x)
def _layernorm(x, axis=-1, eps=1e-5):
    m = x.mean(dim=axis, keepdim=True)
    v = x.var(dim=axis, keepdim=True, unbiased=False)
    return (x - m) / torch.sqrt(v + eps)
def _scatter_add(tgt, idx, src, axis=0):
    return tgt.clone().index_add_(axis, idx, src)
def _segment_sum(src, seg, n):
    out = torch.zeros((n,) + src.shape[1:], dtype=src.dtype)
    return out.index_add_(0, seg, src)
def _pad(x, pw):
    flat = tuple(v for pair in reversed(pw) for v in pair)
    return torch.nn.functional.pad(x, flat)

kernel_name = 'recurrent_scan__sliding_block_cached__swiglu_ffn__decode'

def setup_inputs():

    _w = (lambda a: (lambda t: t.to(torch.bfloat16) if t.is_floating_point() else t)(torch.as_tensor(a)))
    def _A_setup():
        B, Sq, D = 1, 1, 640
        Hq, Hkv, Sk, Dh = 32, 32, 32768, 128
        assert Hq % Hkv == 0, (Hq, Hkv)
        return {
            "x": _w((lambda *s: torch.randn(*s, dtype=torch.bfloat16) * 0.05)(B, Sq, D)),
            "k_cache": _w((lambda *s: torch.randn(*s, dtype=torch.bfloat16) * 1.6)(B, Hkv, Sk, Dh)),
            "v_cache": _w((lambda *s: torch.randn(*s, dtype=torch.bfloat16) * 0.2)(B, Hkv, Sk, Dh)),
            "wq": _w((lambda *s: torch.randn(*s, dtype=torch.bfloat16) * 1.6)(D, Hq * Dh) * (D ** -0.5)),
            "wo": _w((lambda *s: torch.randn(*s, dtype=torch.bfloat16) * 0.2)(Hq * Dh, D) * ((Hq * Dh) ** -0.5)),
        }
    _A_in = _A_setup()

    def _B_setup():
        B, S, D, F = 1, 1, 640, 1728
        return {
            "x": _w((lambda *s: torch.randn(*s, dtype=torch.bfloat16) * 0.05)(B, S, D)),
            "w_gate": _w((lambda *s: torch.randn(*s, dtype=torch.bfloat16) * 0.1)(D, F)),
            "w_up": _w((lambda *s: torch.randn(*s, dtype=torch.bfloat16) * 0.1)(D, F)),
            "w_down": _w((lambda *s: torch.randn(*s, dtype=torch.bfloat16) * 0.1)(F, D)),
        }
    _B_in = _B_setup()

    return {
        "A_x": _A_in["x"],
        "A_k_cache": _A_in["k_cache"],
        "A_v_cache": _A_in["v_cache"],
        "A_wq": _A_in["wq"],
        "A_wo": _A_in["wo"],
        "B_x": _B_in["x"],
        "B_w_gate": _B_in["w_gate"],
        "B_w_up": _B_in["w_up"],
        "B_w_down": _B_in["w_down"],
    }

def reference(A_x, A_k_cache, A_v_cache, A_wq, A_wo, B_x, B_w_gate, B_w_up, B_w_down):
    def _A_ref(x, k_cache, v_cache, wq, wo):
        B, Sq, D = x.shape
        Hq, Dh = 32, 128
        Hkv, Sk = k_cache.shape[1], k_cache.shape[2]
        W = min(4096, max(256, Sk // 4))
        rep = Hq // Hkv
        q = (lambda x, *d: x.permute(*d))((x @ wq).reshape(B, Sq, Hq, Dh), 0, 2, 1, 3)
        k = (lambda x, n, axis: torch.repeat_interleave(x, n, dim=axis))(k_cache[:, :, Sk - W:, :], rep, axis=1)
        v = (lambda x, n, axis: torch.repeat_interleave(x, n, dim=axis))(v_cache[:, :, Sk - W:, :], rep, axis=1)
        scores = torch.einsum("bhqd,bhkd->bhqk", q, k) * (Dh ** -0.5)
        p = _softmax(scores, axis=-1)
        o = torch.einsum("bhqk,bhkd->bhqd", p, v)
        return (lambda x, *d: x.permute(*d))(o, 0, 2, 1, 3).reshape(B, Sq, Hq * Dh) @ wo

    def _B_ref(x, w_gate, w_up, w_down):
        g = _silu(x @ w_gate)
        u = x @ w_up
        return (g * u) @ w_down

    x = A_x
    xn = _layernorm(x, axis=-1)
    s = _A_ref(xn, A_k_cache, A_v_cache, A_wq, A_wo)
    g = _silu(_B_ref(xn, B_w_gate, B_w_up, B_w_down))
    return x + s * g
```

```asm
; @launch grid=(256,1,1) block=(768,1,1) lds=12288
.amdgcn_target "amdgcn-amd-amdhsa--gfx950"
.text
.globl recurrent_scan__sliding_block_cached__swiglu_ffn__decode_kernel
.p2align 8
.type recurrent_scan__sliding_block_cached__swiglu_ffn__decode_kernel,@function
recurrent_scan__sliding_block_cached__swiglu_ffn__decode_kernel:
    s_load_dwordx16 s[4:19], s[0:1], 0
    s_load_dwordx8 s[20:27], s[0:1], 64
    v_lshrrev_b32 v1, 6, v0
    s_cmpk_ge_u32 s2, 256
    v_readfirstlane_b32 s3, v1
    s_cbranch_scc1 L_exit
    v_and_b32 v0, 63, v0
    s_and_b32 s28, s2, 31
    s_bitcmp1_b32 0x12000000, s28
    s_cselect_b32 s46, 5, 0
    s_xor_b32 s28, s28, s46
    s_lshr_b32 s29, s2, 5
    s_cmp_lt_u32 s3, 4
    s_cbranch_scc1 L_aux
    s_and_b32 s31, s3, 3
    s_lshl_b32 s36, s28, 6
    s_add_u32 s36, s36, s29
    s_add_u32 s36, s36, 56
    s_lshl_b32 s36, s36, 17
    s_xor_b32 s37, s2, s31
    s_lshl_b32 s37, s37, 25
    s_lshr_b32 s37, s37, 15
    s_or_b32 s36, s36, s37
    v_lshlrev_b32 v1, 4, v0
    s_brev_b32 s34, 8
    s_mov_b32 s35, 0x20000
    s_setprio 2
    s_cmp_lt_u32 s3, 8
    s_cbranch_scc1 L_kv1
    s_setprio 1
    s_barrier
L_kv1:
    s_waitcnt lgkmcnt(0)
    s_cselect_b32 s32, s6, s8
    s_cselect_b32 s33, s7, s9
    buffer_load_dwordx4 v[8:11], v1, s[32:35], s36 offen nt
    s_xor_b32 s37, s36, 4096
    buffer_load_dwordx4 v[12:15], v1, s[32:35], s37 offen nt
    s_xor_b32 s37, s36, 8192
    buffer_load_dwordx4 v[16:19], v1, s[32:35], s37 offen nt
    s_xor_b32 s37, s36, 12288
    buffer_load_dwordx4 v[20:23], v1, s[32:35], s37 offen nt
    s_load_dword s56, s[26:27], 397312
    s_cmp_lt_u32 s3, 8
    s_cbranch_scc0 L_kv2
    s_barrier
L_kv2:
    s_xor_b32 s37, s36, 16384
    buffer_load_dwordx4 v[24:27], v1, s[32:35], s37 offen nt
    s_xor_b32 s37, s36, 20480
    buffer_load_dwordx4 v[28:31], v1, s[32:35], s37 offen nt
    s_xor_b32 s37, s36, 24576
    buffer_load_dwordx4 v[32:35], v1, s[32:35], s37 offen nt
    s_xor_b32 s37, s36, 28672
    buffer_load_dwordx4 v[36:39], v1, s[32:35], s37 offen nt
    s_xor_b32 s37, s36, 32768
    buffer_load_dwordx4 v[40:43], v1, s[32:35], s37 offen nt
    s_xor_b32 s37, s36, 36864
    buffer_load_dwordx4 v[44:47], v1, s[32:35], s37 offen nt
    s_xor_b32 s37, s36, 40960
    buffer_load_dwordx4 v[48:51], v1, s[32:35], s37 offen nt
    s_xor_b32 s37, s36, 45056
    buffer_load_dwordx4 v[52:55], v1, s[32:35], s37 offen nt
    s_xor_b32 s37, s36, 49152
    buffer_load_dwordx4 v[56:59], v1, s[32:35], s37 offen nt
    s_xor_b32 s37, s36, 53248
    buffer_load_dwordx4 v[60:63], v1, s[32:35], s37 offen nt
    s_xor_b32 s37, s36, 57344
    buffer_load_dwordx4 v[64:67], v1, s[32:35], s37 offen nt
    s_xor_b32 s37, s36, 61440
    buffer_load_dwordx4 v[68:71], v1, s[32:35], s37 offen nt
    s_xor_b32 s37, s36, 65536
    buffer_load_dwordx4 v[72:75], v1, s[32:35], s37 offen nt
    s_xor_b32 s37, s36, 69632
    buffer_load_dwordx4 v[76:79], v1, s[32:35], s37 offen nt
    s_xor_b32 s37, s36, 73728
    buffer_load_dwordx4 v[80:83], v1, s[32:35], s37 offen nt
    s_xor_b32 s37, s36, 77824
    buffer_load_dwordx4 v[84:87], v1, s[32:35], s37 offen nt
    s_xor_b32 s37, s36, 81920
    buffer_load_dwordx4 v[88:91], v1, s[32:35], s37 offen nt
    s_xor_b32 s37, s36, 86016
    buffer_load_dwordx4 v[92:95], v1, s[32:35], s37 offen nt
    s_xor_b32 s37, s36, 90112
    buffer_load_dwordx4 v[96:99], v1, s[32:35], s37 offen nt
    s_xor_b32 s37, s36, 94208
    buffer_load_dwordx4 v[100:103], v1, s[32:35], s37 offen nt
    s_xor_b32 s37, s36, 98304
    buffer_load_dwordx4 v[104:107], v1, s[32:35], s37 offen nt
    s_xor_b32 s37, s36, 102400
    buffer_load_dwordx4 v[108:111], v1, s[32:35], s37 offen nt
    s_xor_b32 s37, s36, 106496
    buffer_load_dwordx4 v[112:115], v1, s[32:35], s37 offen nt
    s_xor_b32 s37, s36, 110592
    buffer_load_dwordx4 v[116:119], v1, s[32:35], s37 offen nt
    s_xor_b32 s37, s36, 114688
    buffer_load_dwordx4 v[120:123], v1, s[32:35], s37 offen nt
    s_xor_b32 s37, s36, 118784
    buffer_load_dwordx4 v[124:127], v1, s[32:35], s37 offen nt
    s_xor_b32 s37, s36, 122880
    buffer_load_dwordx4 v[128:131], v1, s[32:35], s37 offen nt
    s_xor_b32 s37, s36, 126976
    buffer_load_dwordx4 v[132:135], v1, s[32:35], s37 offen nt
    v_mov_b32 v2, 0
    v_and_b32 v3, 15, v0
    s_mov_b32 s38, 1048576
    s_lshl_b32 s30, s28, 3
    s_add_u32 s30, s30, s29
    v_and_b32 v156, 1, v3
    v_lshlrev_b32 v156, 4, v156
    v_mov_b32 v157, 0xffff
    v_lshlrev_b32 v157, v156, v157
    v_lshrrev_b32 v156, 1, v3
    v_cmp_eq_u32 s[48:49], 0, v156
    v_cmp_eq_u32 s[50:51], 1, v156
    v_cmp_eq_u32 s[52:53], 2, v156
    v_cmp_eq_u32 s[54:55], 3, v156
    v_cndmask_b32 v136, 0, v157, s[48:49]
    v_cndmask_b32 v137, 0, v157, s[50:51]
    v_cndmask_b32 v138, 0, v157, s[52:53]
    v_cndmask_b32 v139, 0, v157, s[54:55]
    s_waitcnt lgkmcnt(0)
    s_add_u32 s57, s56, 1
    s_movk_i32 s58, 127
    s_movk_i32 s59, 65408
    v_mov_b32 v143, s57
    s_cmp_lt_u32 s3, 8
    s_cbranch_scc1 L_k
    s_lshl_b32 s46, s31, 9
    v_lshl_add_u32 v4, v0, 3, s46
    s_lshl_b32 s46, s31, 2
    v_mov_b32 v5, s46
L_lw1:
    ds_read_b32 v156, v5 offset:144
    ds_read_b64 v[140:141], v4 offset:512
    ds_read_b32 v157, v2 offset:140
    s_waitcnt lgkmcnt(0)
    v_cmp_eq_u32 vcc, 0, v156
    s_cbranch_vccz L_ld2
    s_sleep 1
    s_sub_u32 s38, s38, 1
    s_cbranch_scc0 L_lw1
    s_branch L_end
L_ld2:
    s_setprio 3
    v_readfirstlane_b32 s60, v157
    s_lshl_b32 s47, s30, 9
    s_add_u32 s47, s47, 262144
    v_add_u32 v7, s47, v1
    v_mov_b32 v4, v5
    s_lshl_b32 s46, s31, 10
    v_add_u32 v5, s46, v1
    v_mov_b32 v6, 1
    v_and_b32_dpp v148, v140, v136 row_newbcast:0 row_mask:0xf bank_mask:0xf
    v_and_b32_dpp v149, v140, v137 row_newbcast:0 row_mask:0xf bank_mask:0xf
    v_and_b32_dpp v150, v140, v138 row_newbcast:0 row_mask:0xf bank_mask:0xf
    v_and_b32_dpp v151, v140, v139 row_newbcast:0 row_mask:0xf bank_mask:0xf
    v_and_b32_dpp v152, v140, v136 row_newbcast:1 row_mask:0xf bank_mask:0xf
    v_and_b32_dpp v153, v140, v137 row_newbcast:1 row_mask:0xf bank_mask:0xf
    v_and_b32_dpp v154, v140, v138 row_newbcast:1 row_mask:0xf bank_mask:0xf
    v_and_b32_dpp v155, v140, v139 row_newbcast:1 row_mask:0xf bank_mask:0xf
    s_waitcnt vmcnt(31)
    ds_write_b32 v4, v6 offset:208
    v_mfma_f32_16x16x32_bf16 v[144:147], v[148:151], v[8:11], 0
    v_and_b32_dpp v148, v140, v136 row_newbcast:2 row_mask:0xf bank_mask:0xf
    v_and_b32_dpp v149, v140, v137 row_newbcast:2 row_mask:0xf bank_mask:0xf
    v_and_b32_dpp v150, v140, v138 row_newbcast:2 row_mask:0xf bank_mask:0xf
    v_and_b32_dpp v151, v140, v139 row_newbcast:2 row_mask:0xf bank_mask:0xf
    s_waitcnt vmcnt(30)
    v_mfma_f32_16x16x32_bf16 v[144:147], v[152:155], v[12:15], v[144:147]
    v_and_b32_dpp v152, v140, v136 row_newbcast:3 row_mask:0xf bank_mask:0xf
    v_and_b32_dpp v153, v140, v137 row_newbcast:3 row_mask:0xf bank_mask:0xf
    v_and_b32_dpp v154, v140, v138 row_newbcast:3 row_mask:0xf bank_mask:0xf
    v_and_b32_dpp v155, v140, v139 row_newbcast:3 row_mask:0xf bank_mask:0xf
    s_waitcnt vmcnt(29)
    v_mfma_f32_16x16x32_bf16 v[144:147], v[148:151], v[16:19], v[144:147]
    v_and_b32_dpp v148, v140, v136 row_newbcast:4 row_mask:0xf bank_mask:0xf
    v_and_b32_dpp v149, v140, v137 row_newbcast:4 row_mask:0xf bank_mask:0xf
    v_and_b32_dpp v150, v140, v138 row_newbcast:4 row_mask:0xf bank_mask:0xf
    v_and_b32_dpp v151, v140, v139 row_newbcast:4 row_mask:0xf bank_mask:0xf
    s_waitcnt vmcnt(28)
    v_mfma_f32_16x16x32_bf16 v[144:147], v[152:155], v[20:23], v[144:147]
    v_and_b32_dpp v152, v140, v136 row_newbcast:5 row_mask:0xf bank_mask:0xf
    v_and_b32_dpp v153, v140, v137 row_newbcast:5 row_mask:0xf bank_mask:0xf
    v_and_b32_dpp v154, v140, v138 row_newbcast:5 row_mask:0xf bank_mask:0xf
    v_and_b32_dpp v155, v140, v139 row_newbcast:5 row_mask:0xf bank_mask:0xf
    s_waitcnt vmcnt(27)
    v_mfma_f32_16x16x32_bf16 v[144:147], v[148:151], v[24:27], v[144:147]
    v_and_b32_dpp v148, v140, v136 row_newbcast:6 row_mask:0xf bank_mask:0xf
    v_and_b32_dpp v149, v140, v137 row_newbcast:6 row_mask:0xf bank_mask:0xf
    v_and_b32_dpp v150, v140, v138 row_newbcast:6 row_mask:0xf bank_mask:0xf
    v_and_b32_dpp v151, v140, v139 row_newbcast:6 row_mask:0xf bank_mask:0xf
    s_waitcnt vmcnt(26)
    v_mfma_f32_16x16x32_bf16 v[144:147], v[152:155], v[28:31], v[144:147]
    v_and_b32_dpp v152, v140, v136 row_newbcast:7 row_mask:0xf bank_mask:0xf
    v_and_b32_dpp v153, v140, v137 row_newbcast:7 row_mask:0xf bank_mask:0xf
    v_and_b32_dpp v154, v140, v138 row_newbcast:7 row_mask:0xf bank_mask:0xf
    v_and_b32_dpp v155, v140, v139 row_newbcast:7 row_mask:0xf bank_mask:0xf
    s_waitcnt vmcnt(25)
    v_mfma_f32_16x16x32_bf16 v[144:147], v[148:151], v[32:35], v[144:147]
    v_and_b32_dpp v148, v140, v136 row_newbcast:8 row_mask:0xf bank_mask:0xf
    v_and_b32_dpp v149, v140, v137 row_newbcast:8 row_mask:0xf bank_mask:0xf
    v_and_b32_dpp v150, v140, v138 row_newbcast:8 row_mask:0xf bank_mask:0xf
    v_and_b32_dpp v151, v140, v139 row_newbcast:8 row_mask:0xf bank_mask:0xf
    s_waitcnt vmcnt(24)
    v_mfma_f32_16x16x32_bf16 v[144:147], v[152:155], v[36:39], v[144:147]
    v_and_b32_dpp v152, v140, v136 row_newbcast:9 row_mask:0xf bank_mask:0xf
    v_and_b32_dpp v153, v140, v137 row_newbcast:9 row_mask:0xf bank_mask:0xf
    v_and_b32_dpp v154, v140, v138 row_newbcast:9 row_mask:0xf bank_mask:0xf
    v_and_b32_dpp v155, v140, v139 row_newbcast:9 row_mask:0xf bank_mask:0xf
    s_waitcnt vmcnt(23)
    v_mfma_f32_16x16x32_bf16 v[144:147], v[148:151], v[40:43], v[144:147]
    v_and_b32_dpp v148, v140, v136 row_newbcast:10 row_mask:0xf bank_mask:0xf
    v_and_b32_dpp v149, v140, v137 row_newbcast:10 row_mask:0xf bank_mask:0xf
    v_and_b32_dpp v150, v140, v138 row_newbcast:10 row_mask:0xf bank_mask:0xf
    v_and_b32_dpp v151, v140, v139 row_newbcast:10 row_mask:0xf bank_mask:0xf
    s_waitcnt vmcnt(22)
    v_mfma_f32_16x16x32_bf16 v[144:147], v[152:155], v[44:47], v[144:147]
    v_and_b32_dpp v152, v140, v136 row_newbcast:11 row_mask:0xf bank_mask:0xf
    v_and_b32_dpp v153, v140, v137 row_newbcast:11 row_mask:0xf bank_mask:0xf
    v_and_b32_dpp v154, v140, v138 row_newbcast:11 row_mask:0xf bank_mask:0xf
    v_and_b32_dpp v155, v140, v139 row_newbcast:11 row_mask:0xf bank_mask:0xf
    s_waitcnt vmcnt(21)
    v_mfma_f32_16x16x32_bf16 v[144:147], v[148:151], v[48:51], v[144:147]
    v_and_b32_dpp v148, v140, v136 row_newbcast:12 row_mask:0xf bank_mask:0xf
    v_and_b32_dpp v149, v140, v137 row_newbcast:12 row_mask:0xf bank_mask:0xf
    v_and_b32_dpp v150, v140, v138 row_newbcast:12 row_mask:0xf bank_mask:0xf
    v_and_b32_dpp v151, v140, v139 row_newbcast:12 row_mask:0xf bank_mask:0xf
    s_waitcnt vmcnt(20)
    v_mfma_f32_16x16x32_bf16 v[144:147], v[152:155], v[52:55], v[144:147]
    v_and_b32_dpp v152, v140, v136 row_newbcast:13 row_mask:0xf bank_mask:0xf
    v_and_b32_dpp v153, v140, v137 row_newbcast:13 row_mask:0xf bank_mask:0xf
    v_and_b32_dpp v154, v140, v138 row_newbcast:13 row_mask:0xf bank_mask:0xf
    v_and_b32_dpp v155, v140, v139 row_newbcast:13 row_mask:0xf bank_mask:0xf
    s_waitcnt vmcnt(19)
    v_mfma_f32_16x16x32_bf16 v[144:147], v[148:151], v[56:59], v[144:147]
    v_and_b32_dpp v148, v140, v136 row_newbcast:14 row_mask:0xf bank_mask:0xf
    v_and_b32_dpp v149, v140, v137 row_newbcast:14 row_mask:0xf bank_mask:0xf
    v_and_b32_dpp v150, v140, v138 row_newbcast:14 row_mask:0xf bank_mask:0xf
    v_and_b32_dpp v151, v140, v139 row_newbcast:14 row_mask:0xf bank_mask:0xf
    s_waitcnt vmcnt(18)
    v_mfma_f32_16x16x32_bf16 v[144:147], v[152:155], v[60:63], v[144:147]
    v_and_b32_dpp v152, v140, v136 row_newbcast:15 row_mask:0xf bank_mask:0xf
    v_and_b32_dpp v153, v140, v137 row_newbcast:15 row_mask:0xf bank_mask:0xf
    v_and_b32_dpp v154, v140, v138 row_newbcast:15 row_mask:0xf bank_mask:0xf
    v_and_b32_dpp v155, v140, v139 row_newbcast:15 row_mask:0xf bank_mask:0xf
    s_waitcnt vmcnt(17)
    v_mfma_f32_16x16x32_bf16 v[144:147], v[148:151], v[64:67], v[144:147]
    v_and_b32_dpp v148, v141, v136 row_newbcast:0 row_mask:0xf bank_mask:0xf
    v_and_b32_dpp v149, v141, v137 row_newbcast:0 row_mask:0xf bank_mask:0xf
    v_and_b32_dpp v150, v141, v138 row_newbcast:0 row_mask:0xf bank_mask:0xf
    v_and_b32_dpp v151, v141, v139 row_newbcast:0 row_mask:0xf bank_mask:0xf
    s_waitcnt vmcnt(16)
    v_mfma_f32_16x16x32_bf16 v[144:147], v[152:155], v[68:71], v[144:147]
    v_and_b32_dpp v152, v141, v136 row_newbcast:1 row_mask:0xf bank_mask:0xf
    v_and_b32_dpp v153, v141, v137 row_newbcast:1 row_mask:0xf bank_mask:0xf
    v_and_b32_dpp v154, v141, v138 row_newbcast:1 row_mask:0xf bank_mask:0xf
    v_and_b32_dpp v155, v141, v139 row_newbcast:1 row_mask:0xf bank_mask:0xf
    s_waitcnt vmcnt(15)
    ds_write_b32 v4, v6 offset:192
    v_mfma_f32_16x16x32_bf16 v[144:147], v[148:151], v[72:75], v[144:147]
    v_and_b32_dpp v148, v141, v136 row_newbcast:2 row_mask:0xf bank_mask:0xf
    v_and_b32_dpp v149, v141, v137 row_newbcast:2 row_mask:0xf bank_mask:0xf
    v_and_b32_dpp v150, v141, v138 row_newbcast:2 row_mask:0xf bank_mask:0xf
    v_and_b32_dpp v151, v141, v139 row_newbcast:2 row_mask:0xf bank_mask:0xf
    s_waitcnt vmcnt(14)
    v_mfma_f32_16x16x32_bf16 v[144:147], v[152:155], v[76:79], v[144:147]
    v_and_b32_dpp v152, v141, v136 row_newbcast:3 row_mask:0xf bank_mask:0xf
    v_and_b32_dpp v153, v141, v137 row_newbcast:3 row_mask:0xf bank_mask:0xf
    v_and_b32_dpp v154, v141, v138 row_newbcast:3 row_mask:0xf bank_mask:0xf
    v_and_b32_dpp v155, v141, v139 row_newbcast:3 row_mask:0xf bank_mask:0xf
    s_waitcnt vmcnt(13)
    v_mfma_f32_16x16x32_bf16 v[144:147], v[148:151], v[80:83], v[144:147]
    v_and_b32_dpp v148, v141, v136 row_newbcast:4 row_mask:0xf bank_mask:0xf
    v_and_b32_dpp v149, v141, v137 row_newbcast:4 row_mask:0xf bank_mask:0xf
    v_and_b32_dpp v150, v141, v138 row_newbcast:4 row_mask:0xf bank_mask:0xf
    v_and_b32_dpp v151, v141, v139 row_newbcast:4 row_mask:0xf bank_mask:0xf
    s_waitcnt vmcnt(12)
    v_mfma_f32_16x16x32_bf16 v[144:147], v[152:155], v[84:87], v[144:147]
    v_and_b32_dpp v152, v141, v136 row_newbcast:5 row_mask:0xf bank_mask:0xf
    v_and_b32_dpp v153, v141, v137 row_newbcast:5 row_mask:0xf bank_mask:0xf
    v_and_b32_dpp v154, v141, v138 row_newbcast:5 row_mask:0xf bank_mask:0xf
    v_and_b32_dpp v155, v141, v139 row_newbcast:5 row_mask:0xf bank_mask:0xf
    s_waitcnt vmcnt(11)
    v_mfma_f32_16x16x32_bf16 v[144:147], v[148:151], v[88:91], v[144:147]
    v_and_b32_dpp v148, v141, v136 row_newbcast:6 row_mask:0xf bank_mask:0xf
    v_and_b32_dpp v149, v141, v137 row_newbcast:6 row_mask:0xf bank_mask:0xf
    v_and_b32_dpp v150, v141, v138 row_newbcast:6 row_mask:0xf bank_mask:0xf
    v_and_b32_dpp v151, v141, v139 row_newbcast:6 row_mask:0xf bank_mask:0xf
    s_waitcnt vmcnt(10)
    v_mfma_f32_16x16x32_bf16 v[144:147], v[152:155], v[92:95], v[144:147]
    v_and_b32_dpp v152, v141, v136 row_newbcast:7 row_mask:0xf bank_mask:0xf
    v_and_b32_dpp v153, v141, v137 row_newbcast:7 row_mask:0xf bank_mask:0xf
    v_and_b32_dpp v154, v141, v138 row_newbcast:7 row_mask:0xf bank_mask:0xf
    v_and_b32_dpp v155, v141, v139 row_newbcast:7 row_mask:0xf bank_mask:0xf
    s_waitcnt vmcnt(9)
    v_mfma_f32_16x16x32_bf16 v[144:147], v[148:151], v[96:99], v[144:147]
    v_and_b32_dpp v148, v141, v136 row_newbcast:8 row_mask:0xf bank_mask:0xf
    v_and_b32_dpp v149, v141, v137 row_newbcast:8 row_mask:0xf bank_mask:0xf
    v_and_b32_dpp v150, v141, v138 row_newbcast:8 row_mask:0xf bank_mask:0xf
    v_and_b32_dpp v151, v141, v139 row_newbcast:8 row_mask:0xf bank_mask:0xf
    s_waitcnt vmcnt(8)
    v_mfma_f32_16x16x32_bf16 v[144:147], v[152:155], v[100:103], v[144:147]
    v_and_b32_dpp v152, v141, v136 row_newbcast:9 row_mask:0xf bank_mask:0xf
    v_and_b32_dpp v153, v141, v137 row_newbcast:9 row_mask:0xf bank_mask:0xf
    v_and_b32_dpp v154, v141, v138 row_newbcast:9 row_mask:0xf bank_mask:0xf
    v_and_b32_dpp v155, v141, v139 row_newbcast:9 row_mask:0xf bank_mask:0xf
    s_waitcnt vmcnt(7)
    v_mfma_f32_16x16x32_bf16 v[144:147], v[148:151], v[104:107], v[144:147]
    v_and_b32_dpp v148, v141, v136 row_newbcast:10 row_mask:0xf bank_mask:0xf
    v_and_b32_dpp v149, v141, v137 row_newbcast:10 row_mask:0xf bank_mask:0xf
    v_and_b32_dpp v150, v141, v138 row_newbcast:10 row_mask:0xf bank_mask:0xf
    v_and_b32_dpp v151, v141, v139 row_newbcast:10 row_mask:0xf bank_mask:0xf
    s_waitcnt vmcnt(6)
    v_mfma_f32_16x16x32_bf16 v[144:147], v[152:155], v[108:111], v[144:147]
    v_and_b32_dpp v152, v141, v136 row_newbcast:11 row_mask:0xf bank_mask:0xf
    v_and_b32_dpp v153, v141, v137 row_newbcast:11 row_mask:0xf bank_mask:0xf
    v_and_b32_dpp v154, v141, v138 row_newbcast:11 row_mask:0xf bank_mask:0xf
    v_and_b32_dpp v155, v141, v139 row_newbcast:11 row_mask:0xf bank_mask:0xf
    s_waitcnt vmcnt(5)
    v_mfma_f32_16x16x32_bf16 v[144:147], v[148:151], v[112:115], v[144:147]
    v_and_b32_dpp v148, v141, v136 row_newbcast:12 row_mask:0xf bank_mask:0xf
    v_and_b32_dpp v149, v141, v137 row_newbcast:12 row_mask:0xf bank_mask:0xf
    v_and_b32_dpp v150, v141, v138 row_newbcast:12 row_mask:0xf bank_mask:0xf
    v_and_b32_dpp v151, v141, v139 row_newbcast:12 row_mask:0xf bank_mask:0xf
    s_waitcnt vmcnt(4)
    v_mfma_f32_16x16x32_bf16 v[144:147], v[152:155], v[116:119], v[144:147]
    v_and_b32_dpp v152, v141, v136 row_newbcast:13 row_mask:0xf bank_mask:0xf
    v_and_b32_dpp v153, v141, v137 row_newbcast:13 row_mask:0xf bank_mask:0xf
    v_and_b32_dpp v154, v141, v138 row_newbcast:13 row_mask:0xf bank_mask:0xf
    v_and_b32_dpp v155, v141, v139 row_newbcast:13 row_mask:0xf bank_mask:0xf
    s_waitcnt vmcnt(3)
    v_mfma_f32_16x16x32_bf16 v[144:147], v[148:151], v[120:123], v[144:147]
    v_and_b32_dpp v148, v141, v136 row_newbcast:14 row_mask:0xf bank_mask:0xf
    v_and_b32_dpp v149, v141, v137 row_newbcast:14 row_mask:0xf bank_mask:0xf
    v_and_b32_dpp v150, v141, v138 row_newbcast:14 row_mask:0xf bank_mask:0xf
    v_and_b32_dpp v151, v141, v139 row_newbcast:14 row_mask:0xf bank_mask:0xf
    s_waitcnt vmcnt(2)
    v_mfma_f32_16x16x32_bf16 v[144:147], v[152:155], v[124:127], v[144:147]
    v_and_b32_dpp v152, v141, v136 row_newbcast:15 row_mask:0xf bank_mask:0xf
    v_and_b32_dpp v153, v141, v137 row_newbcast:15 row_mask:0xf bank_mask:0xf
    v_and_b32_dpp v154, v141, v138 row_newbcast:15 row_mask:0xf bank_mask:0xf
    v_and_b32_dpp v155, v141, v139 row_newbcast:15 row_mask:0xf bank_mask:0xf
    s_waitcnt vmcnt(1)
    v_mfma_f32_16x16x32_bf16 v[144:147], v[148:151], v[128:131], v[144:147]
    s_waitcnt vmcnt(0)
    v_mfma_f32_16x16x32_bf16 v[144:147], v[152:155], v[132:135], v[144:147]
    s_nop 7
    ds_write_b128 v5, v[144:147] offset:4096
    s_mov_b64 exec, 1
    ds_add_rtn_u32 v6, v2, v6 offset:160
    s_mov_b64 exec, -1
    ds_read_b128 v[156:159], v1 offset:4096
    ds_read_b128 v[160:163], v1 offset:5120
    ds_read_b128 v[164:167], v1 offset:6144
    ds_read_b128 v[148:151], v1 offset:7168
    s_waitcnt lgkmcnt(0)
    v_readfirstlane_b32 s46, v6
    v_pk_add_f32 v[156:157], v[156:157], v[160:161]
    v_pk_add_f32 v[158:159], v[158:159], v[162:163]
    v_pk_add_f32 v[164:165], v[164:165], v[148:149]
    v_pk_add_f32 v[166:167], v[166:167], v[150:151]
    s_cmp_eq_u32 s46, 3
    s_cbranch_scc0 L_end
    v_pk_add_f32 v[156:157], v[156:157], v[164:165]
    v_pk_add_f32 v[158:159], v[158:159], v[166:167]
    v_bfi_b32 v156, s58, v143, v156
    v_bfi_b32 v157, s58, v143, v157
    v_bfi_b32 v158, s58, v143, v158
    v_bfi_b32 v159, s58, v143, v159
    s_mov_b32 exec_hi, 0
    s_cmp_eq_u32 s60, 1
    s_cbranch_scc0 L_gs3
    global_store_dwordx4 v7, v[156:159], s[26:27]
    s_branch L_gt4
L_gs3:
    global_store_dwordx4 v7, v[156:159], s[26:27] sc1
L_gt4:
    v_mov_b32 v160, 1
    ds_write_b32 v2, v160 offset:224
    s_branch L_end
L_k:
    v_lshlrev_b32 v4, 4, v3
    s_mov_b32 s40, 0xcccccccc
    s_mov_b32 s41, 0xcccccccc
    s_mov_b32 s42, 0xaaaaaaaa
    s_mov_b32 s43, 0xaaaaaaaa
L_lw5:
    ds_read_b32 v156, v2 offset:136
    ds_read_b128 v[160:163], v4 offset:256
    ds_read_b32 v157, v2 offset:140
    s_waitcnt lgkmcnt(0)
    v_cmp_eq_u32 vcc, 0, v156
    s_cbranch_vccz L_ld6
    s_sleep 2
    s_sub_u32 s38, s38, 1
    s_cbranch_scc0 L_lw5
    s_branch L_end
L_ld6:
    s_setprio 3
    v_readfirstlane_b32 s60, v157
    s_waitcnt vmcnt(16)
    v_dot2_f32_bf16 v8, v8, v160, 0
    v_dot2_f32_bf16 v12, v12, v160, 0
    v_dot2_f32_bf16 v16, v16, v160, 0
    v_dot2_f32_bf16 v20, v20, v160, 0
    v_dot2c_f32_bf16 v8, v9, v161
    v_dot2c_f32_bf16 v12, v13, v161
    v_dot2c_f32_bf16 v16, v17, v161
    v_dot2c_f32_bf16 v20, v21, v161
    v_dot2c_f32_bf16 v8, v10, v162
    v_dot2c_f32_bf16 v12, v14, v162
    v_dot2c_f32_bf16 v16, v18, v162
    v_dot2c_f32_bf16 v20, v22, v162
    v_dot2c_f32_bf16 v8, v11, v163
    v_dot2c_f32_bf16 v12, v15, v163
    v_dot2c_f32_bf16 v16, v19, v163
    v_dot2c_f32_bf16 v20, v23, v163
    v_dot2_f32_bf16 v24, v24, v160, 0
    v_dot2_f32_bf16 v28, v28, v160, 0
    v_dot2_f32_bf16 v32, v32, v160, 0
    v_dot2_f32_bf16 v36, v36, v160, 0
    v_dot2c_f32_bf16 v24, v25, v161
    v_dot2c_f32_bf16 v28, v29, v161
    v_dot2c_f32_bf16 v32, v33, v161
    v_dot2c_f32_bf16 v36, v37, v161
    v_dot2c_f32_bf16 v24, v26, v162
    v_dot2c_f32_bf16 v28, v30, v162
    v_dot2c_f32_bf16 v32, v34, v162
    v_dot2c_f32_bf16 v36, v38, v162
    v_dot2c_f32_bf16 v24, v27, v163
    v_dot2c_f32_bf16 v28, v31, v163
    v_dot2c_f32_bf16 v32, v35, v163
    v_dot2c_f32_bf16 v36, v39, v163
    v_dot2_f32_bf16 v40, v40, v160, 0
    v_dot2_f32_bf16 v44, v44, v160, 0
    v_dot2_f32_bf16 v48, v48, v160, 0
    v_dot2_f32_bf16 v52, v52, v160, 0
    v_dot2c_f32_bf16 v40, v41, v161
    v_dot2c_f32_bf16 v44, v45, v161
    v_dot2c_f32_bf16 v48, v49, v161
    v_dot2c_f32_bf16 v52, v53, v161
    v_dot2c_f32_bf16 v40, v42, v162
    v_dot2c_f32_bf16 v44, v46, v162
    v_dot2c_f32_bf16 v48, v50, v162
    v_dot2c_f32_bf16 v52, v54, v162
    v_dot2c_f32_bf16 v40, v43, v163
    v_dot2c_f32_bf16 v44, v47, v163
    v_dot2c_f32_bf16 v48, v51, v163
    v_dot2c_f32_bf16 v52, v55, v163
    v_dot2_f32_bf16 v56, v56, v160, 0
    v_dot2_f32_bf16 v60, v60, v160, 0
    v_dot2_f32_bf16 v64, v64, v160, 0
    v_dot2_f32_bf16 v68, v68, v160, 0
    v_dot2c_f32_bf16 v56, v57, v161
    v_dot2c_f32_bf16 v60, v61, v161
    v_dot2c_f32_bf16 v64, v65, v161
    v_dot2c_f32_bf16 v68, v69, v161
    v_dot2c_f32_bf16 v56, v58, v162
    v_dot2c_f32_bf16 v60, v62, v162
    v_dot2c_f32_bf16 v64, v66, v162
    v_dot2c_f32_bf16 v68, v70, v162
    v_dot2c_f32_bf16 v56, v59, v163
    v_dot2c_f32_bf16 v60, v63, v163
    v_dot2c_f32_bf16 v64, v67, v163
    v_dot2c_f32_bf16 v68, v71, v163
    v_add_f32_dpp v8, v8, v8 row_ror:8 row_mask:0xf bank_mask:0x3
    v_add_f32_dpp v24, v24, v24 row_ror:8 row_mask:0xf bank_mask:0x3
    v_add_f32_dpp v16, v16, v16 row_ror:8 row_mask:0xf bank_mask:0x3
    v_add_f32_dpp v32, v32, v32 row_ror:8 row_mask:0xf bank_mask:0x3
    v_add_f32_dpp v12, v12, v12 row_ror:8 row_mask:0xf bank_mask:0x3
    v_add_f32_dpp v28, v28, v28 row_ror:8 row_mask:0xf bank_mask:0x3
    v_add_f32_dpp v20, v20, v20 row_ror:8 row_mask:0xf bank_mask:0x3
    v_add_f32_dpp v36, v36, v36 row_ror:8 row_mask:0xf bank_mask:0x3
    v_add_f32_dpp v8, v40, v40 row_ror:8 row_mask:0xf bank_mask:0xc
    v_add_f32_dpp v24, v56, v56 row_ror:8 row_mask:0xf bank_mask:0xc
    v_add_f32_dpp v16, v48, v48 row_ror:8 row_mask:0xf bank_mask:0xc
    v_add_f32_dpp v32, v64, v64 row_ror:8 row_mask:0xf bank_mask:0xc
    v_add_f32_dpp v12, v44, v44 row_ror:8 row_mask:0xf bank_mask:0xc
    v_add_f32_dpp v28, v60, v60 row_ror:8 row_mask:0xf bank_mask:0xc
    v_add_f32_dpp v20, v52, v52 row_ror:8 row_mask:0xf bank_mask:0xc
    v_add_f32_dpp v36, v68, v68 row_ror:8 row_mask:0xf bank_mask:0xc
    v_add_f32_dpp v8, v8, v8 row_half_mirror row_mask:0xf bank_mask:0x5
    v_add_f32_dpp v16, v16, v16 row_half_mirror row_mask:0xf bank_mask:0x5
    v_add_f32_dpp v12, v12, v12 row_half_mirror row_mask:0xf bank_mask:0x5
    v_add_f32_dpp v20, v20, v20 row_half_mirror row_mask:0xf bank_mask:0x5
    v_add_f32_dpp v8, v24, v24 row_half_mirror row_mask:0xf bank_mask:0xa
    v_add_f32_dpp v16, v32, v32 row_half_mirror row_mask:0xf bank_mask:0xa
    v_add_f32_dpp v12, v28, v28 row_half_mirror row_mask:0xf bank_mask:0xa
    v_add_f32_dpp v20, v36, v36 row_half_mirror row_mask:0xf bank_mask:0xa
    v_add_f32_dpp v8, v8, v8 quad_perm:[2,3,0,1] row_mask:0xf bank_mask:0xf
    v_add_f32_dpp v16, v16, v16 quad_perm:[2,3,0,1] row_mask:0xf bank_mask:0xf
    v_add_f32_dpp v12, v12, v12 quad_perm:[2,3,0,1] row_mask:0xf bank_mask:0xf
    v_add_f32_dpp v20, v20, v20 quad_perm:[2,3,0,1] row_mask:0xf bank_mask:0xf
    v_cndmask_b32 v8, v8, v16, s[40:41]
    v_cndmask_b32 v12, v12, v20, s[40:41]
    s_nop 0
    v_add_f32_dpp v8, v8, v8 quad_perm:[1,0,3,2] row_mask:0xf bank_mask:0xf
    v_add_f32_dpp v12, v12, v12 quad_perm:[1,0,3,2] row_mask:0xf bank_mask:0xf
    v_cndmask_b32 v164, v8, v12, s[42:43]
    s_waitcnt vmcnt(0)
    v_dot2_f32_bf16 v72, v72, v160, 0
    v_dot2_f32_bf16 v76, v76, v160, 0
    v_dot2_f32_bf16 v80, v80, v160, 0
    v_dot2_f32_bf16 v84, v84, v160, 0
    v_dot2c_f32_bf16 v72, v73, v161
    v_dot2c_f32_bf16 v76, v77, v161
    v_dot2c_f32_bf16 v80, v81, v161
    v_dot2c_f32_bf16 v84, v85, v161
    v_dot2c_f32_bf16 v72, v74, v162
    v_dot2c_f32_bf16 v76, v78, v162
    v_dot2c_f32_bf16 v80, v82, v162
    v_dot2c_f32_bf16 v84, v86, v162
    v_dot2c_f32_bf16 v72, v75, v163
    v_dot2c_f32_bf16 v76, v79, v163
    v_dot2c_f32_bf16 v80, v83, v163
    v_dot2c_f32_bf16 v84, v87, v163
    v_dot2_f32_bf16 v88, v88, v160, 0
    v_dot2_f32_bf16 v92, v92, v160, 0
    v_dot2_f32_bf16 v96, v96, v160, 0
    v_dot2_f32_bf16 v100, v100, v160, 0
    v_dot2c_f32_bf16 v88, v89, v161
    v_dot2c_f32_bf16 v92, v93, v161
    v_dot2c_f32_bf16 v96, v97, v161
    v_dot2c_f32_bf16 v100, v101, v161
    v_dot2c_f32_bf16 v88, v90, v162
    v_dot2c_f32_bf16 v92, v94, v162
    v_dot2c_f32_bf16 v96, v98, v162
    v_dot2c_f32_bf16 v100, v102, v162
    v_dot2c_f32_bf16 v88, v91, v163
    v_dot2c_f32_bf16 v92, v95, v163
    v_dot2c_f32_bf16 v96, v99, v163
    v_dot2c_f32_bf16 v100, v103, v163
    v_dot2_f32_bf16 v104, v104, v160, 0
    v_dot2_f32_bf16 v108, v108, v160, 0
    v_dot2_f32_bf16 v112, v112, v160, 0
    v_dot2_f32_bf16 v116, v116, v160, 0
    v_dot2c_f32_bf16 v104, v105, v161
    v_dot2c_f32_bf16 v108, v109, v161
    v_dot2c_f32_bf16 v112, v113, v161
    v_dot2c_f32_bf16 v116, v117, v161
    v_dot2c_f32_bf16 v104, v106, v162
    v_dot2c_f32_bf16 v108, v110, v162
    v_dot2c_f32_bf16 v112, v114, v162
    v_dot2c_f32_bf16 v116, v118, v162
    v_dot2c_f32_bf16 v104, v107, v163
    v_dot2c_f32_bf16 v108, v111, v163
    v_dot2c_f32_bf16 v112, v115, v163
    v_dot2c_f32_bf16 v116, v119, v163
    v_dot2_f32_bf16 v120, v120, v160, 0
    v_dot2_f32_bf16 v124, v124, v160, 0
    v_dot2_f32_bf16 v128, v128, v160, 0
    v_dot2_f32_bf16 v132, v132, v160, 0
    v_dot2c_f32_bf16 v120, v121, v161
    v_dot2c_f32_bf16 v124, v125, v161
    v_dot2c_f32_bf16 v128, v129, v161
    v_dot2c_f32_bf16 v132, v133, v161
    v_dot2c_f32_bf16 v120, v122, v162
    v_dot2c_f32_bf16 v124, v126, v162
    v_dot2c_f32_bf16 v128, v130, v162
    v_dot2c_f32_bf16 v132, v134, v162
    v_dot2c_f32_bf16 v120, v123, v163
    v_dot2c_f32_bf16 v124, v127, v163
    v_dot2c_f32_bf16 v128, v131, v163
    v_dot2c_f32_bf16 v132, v135, v163
    v_add_f32_dpp v72, v72, v72 row_ror:8 row_mask:0xf bank_mask:0x3
    v_add_f32_dpp v88, v88, v88 row_ror:8 row_mask:0xf bank_mask:0x3
    v_add_f32_dpp v80, v80, v80 row_ror:8 row_mask:0xf bank_mask:0x3
    v_add_f32_dpp v96, v96, v96 row_ror:8 row_mask:0xf bank_mask:0x3
    v_add_f32_dpp v76, v76, v76 row_ror:8 row_mask:0xf bank_mask:0x3
    v_add_f32_dpp v92, v92, v92 row_ror:8 row_mask:0xf bank_mask:0x3
    v_add_f32_dpp v84, v84, v84 row_ror:8 row_mask:0xf bank_mask:0x3
    v_add_f32_dpp v100, v100, v100 row_ror:8 row_mask:0xf bank_mask:0x3
    v_add_f32_dpp v72, v104, v104 row_ror:8 row_mask:0xf bank_mask:0xc
    v_add_f32_dpp v88, v120, v120 row_ror:8 row_mask:0xf bank_mask:0xc
    v_add_f32_dpp v80, v112, v112 row_ror:8 row_mask:0xf bank_mask:0xc
    v_add_f32_dpp v96, v128, v128 row_ror:8 row_mask:0xf bank_mask:0xc
    v_add_f32_dpp v76, v108, v108 row_ror:8 row_mask:0xf bank_mask:0xc
    v_add_f32_dpp v92, v124, v124 row_ror:8 row_mask:0xf bank_mask:0xc
    v_add_f32_dpp v84, v116, v116 row_ror:8 row_mask:0xf bank_mask:0xc
    v_add_f32_dpp v100, v132, v132 row_ror:8 row_mask:0xf bank_mask:0xc
    v_add_f32_dpp v72, v72, v72 row_half_mirror row_mask:0xf bank_mask:0x5
    v_add_f32_dpp v80, v80, v80 row_half_mirror row_mask:0xf bank_mask:0x5
    v_add_f32_dpp v76, v76, v76 row_half_mirror row_mask:0xf bank_mask:0x5
    v_add_f32_dpp v84, v84, v84 row_half_mirror row_mask:0xf bank_mask:0x5
    v_add_f32_dpp v72, v88, v88 row_half_mirror row_mask:0xf bank_mask:0xa
    v_add_f32_dpp v80, v96, v96 row_half_mirror row_mask:0xf bank_mask:0xa
    v_add_f32_dpp v76, v92, v92 row_half_mirror row_mask:0xf bank_mask:0xa
    v_add_f32_dpp v84, v100, v100 row_half_mirror row_mask:0xf bank_mask:0xa
    v_add_f32_dpp v72, v72, v72 quad_perm:[2,3,0,1] row_mask:0xf bank_mask:0xf
    v_add_f32_dpp v80, v80, v80 quad_perm:[2,3,0,1] row_mask:0xf bank_mask:0xf
    v_add_f32_dpp v76, v76, v76 quad_perm:[2,3,0,1] row_mask:0xf bank_mask:0xf
    v_add_f32_dpp v84, v84, v84 quad_perm:[2,3,0,1] row_mask:0xf bank_mask:0xf
    v_cndmask_b32 v72, v72, v80, s[40:41]
    v_cndmask_b32 v76, v76, v84, s[40:41]
    s_nop 0
    v_add_f32_dpp v72, v72, v72 quad_perm:[1,0,3,2] row_mask:0xf bank_mask:0xf
    v_add_f32_dpp v76, v76, v76 quad_perm:[1,0,3,2] row_mask:0xf bank_mask:0xf
    v_cndmask_b32 v165, v72, v76, s[42:43]
    v_cvt_pk_bf16_f32 v166, v164, v165
    v_lshlrev_b32 v164, 16, v166
    v_and_b32 v165, 0xffff0000, v166
    v_mul_f32 v164, 0x3db504f3, v164
    v_mul_f32 v165, 0x3db504f3, v165
    v_cvt_pk_bf16_f32 v166, v164, v165
    v_lshlrev_b32 v164, 16, v166
    v_and_b32 v165, 0xffff0000, v166
    v_mul_f32 v164, 0x3fb8aa3b, v164
    v_mul_f32 v165, 0x3fb8aa3b, v165
    v_max_f32 v160, v164, v165
    s_nop 1
    v_max_f32_dpp v160, v160, v160 row_ror:8 row_mask:0xf bank_mask:0xf
    s_nop 1
    v_max_f32_dpp v160, v160, v160 row_ror:4 row_mask:0xf bank_mask:0xf
    s_nop 1
    v_max_f32_dpp v160, v160, v160 row_ror:2 row_mask:0xf bank_mask:0xf
    s_nop 1
    v_max_f32_dpp v160, v160, v160 row_ror:1 row_mask:0xf bank_mask:0xf
    v_lshrrev_b32 v5, 4, v0
    s_lshl_b32 s46, s31, 4
    v_lshl_add_u32 v5, v5, 2, s46
    v_lshlrev_b32 v6, 2, v3
    ds_write_b32 v5, v160 offset:0
L_lw7:
    ds_read_b32 v160, v6 offset:0
    s_waitcnt lgkmcnt(0)
    v_cmp_eq_u32 vcc, -1, v160
    s_cbranch_vccz L_ld8
    s_sub_u32 s38, s38, 1
    s_cbranch_scc0 L_lw7
    s_branch L_end
L_ld8:
    v_max_f32_dpp v160, v160, v160 row_ror:8 row_mask:0xf bank_mask:0xf
    s_nop 1
    v_max_f32_dpp v160, v160, v160 row_ror:4 row_mask:0xf bank_mask:0xf
    s_nop 1
    v_max_f32_dpp v160, v160, v160 row_ror:2 row_mask:0xf bank_mask:0xf
    s_nop 1
    v_max_f32_dpp v160, v160, v160 row_ror:1 row_mask:0xf bank_mask:0xf
    v_sub_f32 v164, v164, v160
    v_sub_f32 v165, v165, v160
    v_exp_f32 v164, v164
    v_exp_f32 v165, v165
    s_lshl_b32 s46, s31, 9
    v_lshl_add_u32 v4, v0, 3, s46
    v_cvt_pk_bf16_f32 v140, v164, v164
    v_cvt_pk_bf16_f32 v141, v165, v165
    v_add_f32 v162, v164, v165
    s_lshl_b32 s46, s31, 2
    v_mov_b32 v7, s46
    v_mov_b32 v157, 1
    ds_write_b64 v4, v[140:141] offset:512
    ds_write_b32 v7, v157 offset:144
    v_add_f32_dpp v162, v162, v162 row_ror:8 row_mask:0xf bank_mask:0xf
    s_nop 1
    v_add_f32_dpp v162, v162, v162 row_ror:4 row_mask:0xf bank_mask:0xf
    s_nop 1
    v_add_f32_dpp v162, v162, v162 row_ror:2 row_mask:0xf bank_mask:0xf
    s_nop 1
    v_add_f32_dpp v162, v162, v162 row_ror:1 row_mask:0xf bank_mask:0xf
    ds_write_b32 v5, v162 offset:64
    s_cmp_eq_u32 s31, 0
    s_cselect_b32 s61, 0, -1
    s_cbranch_scc0 L_k2
L_lw9:
    ds_read_b32 v162, v6 offset:64
    s_waitcnt lgkmcnt(0)
    v_cmp_eq_u32 vcc, -1, v162
    s_cbranch_vccz L_ld10
    s_sub_u32 s38, s38, 1
    s_cbranch_scc0 L_lw9
    s_branch L_end
L_ld10:
    v_add_f32_dpp v162, v162, v162 row_ror:8 row_mask:0xf bank_mask:0xf
    s_nop 1
    v_add_f32_dpp v162, v162, v162 row_ror:4 row_mask:0xf bank_mask:0xf
    s_nop 1
    v_add_f32_dpp v162, v162, v162 row_ror:2 row_mask:0xf bank_mask:0xf
    s_nop 1
    v_add_f32_dpp v162, v162, v162 row_ror:1 row_mask:0xf bank_mask:0xf
    s_lshl_b32 s46, s30, 4
    s_add_u32 s46, s46, 393216
    v_mov_b32 v7, s46
    v_mov_b32 v161, v143
    v_mov_b32 v163, v143
    s_mov_b64 exec, 1
    s_cmp_eq_u32 s60, 1
    s_cbranch_scc0 L_gs11
    global_store_dwordx4 v7, v[160:163], s[26:27]
    s_branch L_gt12
L_gs11:
    global_store_dwordx4 v7, v[160:163], s[26:27] sc1
L_gt12:
    s_mov_b64 exec, -1
L_k2:
    v_and_b32 v4, 7, v0
    s_lshl_b32 s46, s28, 12
    s_lshl_b32 s47, s31, 7
    s_add_u32 s46, s46, s47
    s_add_u32 s46, s46, 262144
    v_lshrrev_b32 v40, 3, v0
    v_lshlrev_b32 v40, 4, v40
    v_lshl_add_u32 v40, v4, 9, v40
    v_add_u32 v40, s46, v40
    s_lshl_b32 s46, s28, 7
    s_add_u32 s46, s46, 393216
    v_lshl_add_u32 v42, v4, 4, s46
    s_mul_i32 s46, s2, 640
    s_add_u32 s46, s46, 524288
    v_add_u32 v7, s46, v1
    v_and_b32 v43, 1, v0
    v_lshlrev_b32 v43, 9, v43
    v_bfe_u32 v44, v0, 1, 1
    v_lshl_add_u32 v43, v44, 8, v43
    v_lshrrev_b32 v44, 2, v0
    v_lshl_add_u32 v43, v44, 4, v43
    s_movk_i32 s58, 1023
    s_mov_b32 s32, s12
    s_mov_b32 s33, s13
    s_mov_b32 s34, 5242880
    s_lshl_b32 s46, s28, 7
    s_and_b32 s47, s31, 1
    s_lshl_b32 s47, s47, 6
    s_add_u32 s46, s46, s47
    s_lshr_b32 s47, s31, 1
    s_lshl_b32 s47, s47, 2
    s_add_u32 s46, s46, s47
    s_mul_i32 s36, s46, 1280
    s_mul_i32 s47, s29, 160
    s_add_u32 s36, s36, s47
    s_add_u32 s37, s36, 10240
    v_lshrrev_b32 v41, 4, v0
    v_mul_u32_u24 v41, 20480, v41
    v_lshl_add_u32 v41, v3, 4, v41
    s_lshl_b32 s46, s31, 10
    v_add_u32 v5, s46, v1
    v_mov_b32 v6, 1
    s_mov_b32 s44, 0x03ff03ff
    s_mov_b32 s45, 0x03ff03ff
L_lw13:
    ds_read_b32 v156, v2 offset:176
    s_waitcnt lgkmcnt(0)
    v_cmp_eq_u32 vcc, 0, v156
    s_cbranch_vccz L_ld14
    s_sleep 2
    s_sub_u32 s38, s38, 1
    s_cbranch_scc0 L_lw13
    s_branch L_end
L_ld14:
    s_lshl_b32 s46, s31, 2
    v_mov_b32 v48, s46
L_lw15:
    ds_read_b32 v156, v48 offset:208
    s_waitcnt lgkmcnt(0)
    v_cmp_eq_u32 vcc, 0, v156
    s_cbranch_vccz L_ld16
    s_sleep 2
    s_sub_u32 s38, s38, 1
    s_cbranch_scc0 L_lw15
    s_branch L_end
L_ld16:
L_ml17:
    global_load_dwordx4 v[44:47], v42, s[26:27] sc1 nt
L_lw19:
    ds_read_b32 v156, v48 offset:192
    s_waitcnt lgkmcnt(0)
    v_cmp_eq_u32 vcc, 0, v156
    s_cbranch_vccz L_ld20
    s_sleep 1
    s_sub_u32 s38, s38, 1
    s_cbranch_scc0 L_lw19
    s_branch L_end
L_ld20:
    s_mov_b64 exec, s[44:45]
    buffer_load_dwordx4 v[8:11], v41, s[32:35], s36 offen offset:0 nt
    buffer_load_dwordx4 v[12:15], v41, s[32:35], s36 offen offset:2560 nt
    buffer_load_dwordx4 v[16:19], v41, s[32:35], s36 offen offset:1280 nt
    buffer_load_dwordx4 v[20:23], v41, s[32:35], s36 offen offset:3840 nt
    buffer_load_dwordx4 v[24:27], v41, s[32:35], s37 offen offset:0 nt
    buffer_load_dwordx4 v[28:31], v41, s[32:35], s37 offen offset:2560 nt
    buffer_load_dwordx4 v[32:35], v41, s[32:35], s37 offen offset:1280 nt
    buffer_load_dwordx4 v[36:39], v41, s[32:35], s37 offen offset:3840 nt
    s_mov_b64 exec, -1
    s_waitcnt vmcnt(8)
    v_bitop3_b32 v164, v45, v47, v143 bitop3:0x7e
    v_cmp_ne_u32 vcc, 0, v164
    s_cbranch_vccz L_me18
    s_sleep 1
    s_sub_u32 s38, s38, 1
    s_cbranch_scc0 L_ml17
    s_branch L_end
L_me18:
    v_mov_b32 v45, v44
    s_nop 1
    v_max_f32_dpp v45, v45, v45 quad_perm:[1,0,3,2] row_mask:0xf bank_mask:0xf
    s_nop 1
    v_max_f32_dpp v45, v45, v45 quad_perm:[2,3,0,1] row_mask:0xf bank_mask:0xf
    s_nop 1
    v_max_f32_dpp v45, v45, v45 row_half_mirror row_mask:0xf bank_mask:0xf
    v_sub_f32 v44, v44, v45
    v_exp_f32 v44, v44
    s_nop 0
    v_mul_f32 v46, v46, v44
    s_nop 1
    v_add_f32_dpp v46, v46, v46 quad_perm:[1,0,3,2] row_mask:0xf bank_mask:0xf
    s_nop 1
    v_add_f32_dpp v46, v46, v46 quad_perm:[2,3,0,1] row_mask:0xf bank_mask:0xf
    s_nop 1
    v_add_f32_dpp v46, v46, v46 row_half_mirror row_mask:0xf bank_mask:0xf
    v_rcp_f32 v46, v46
    s_nop 0
    v_mul_f32 v142, v44, v46
L_lw21:
    ds_read_b32 v156, v2 offset:224
    s_waitcnt lgkmcnt(0)
    v_cmp_eq_u32 vcc, 0, v156
    s_cbranch_vccz L_ld22
    s_sub_u32 s38, s38, 1
    s_cbranch_scc0 L_lw21
    s_branch L_end
L_ld22:
    s_waitcnt vmcnt(4)
L_pl23:
    global_load_dwordx4 v[160:163], v40, s[26:27] sc1 nt
L_pe25:
    s_waitcnt vmcnt(0)
    v_bitop3_b32 v164, v160, v161, v143 bitop3:0x7e
    v_bitop3_b32 v165, v162, v163, v143 bitop3:0x7e
    v_or_b32 v164, v164, v165
    v_and_b32 v164, 127, v164
    v_cmp_ne_u32 vcc, 0, v164
    s_cbranch_vccz L_pd24
    s_mov_b64 exec, vcc
    s_sub_u32 s38, s38, 1
    s_cbranch_scc0 L_pl23
    s_branch L_end
L_pd24:
    s_mov_b64 exec, -1
    v_and_or_b32 v160, v160, s59, 64
    v_and_or_b32 v161, v161, s59, 64
    v_and_or_b32 v162, v162, s59, 64
    v_and_or_b32 v163, v163, s59, 64
    v_mul_f32 v160, v142, v160
    v_mul_f32 v161, v142, v161
    v_mul_f32 v162, v142, v162
    v_mul_f32 v163, v142, v163
    v_add_f32_dpp v160, v160, v160 row_half_mirror row_mask:0xf bank_mask:0x5
    v_add_f32_dpp v162, v162, v162 row_half_mirror row_mask:0xf bank_mask:0x5
    s_nop 0
    v_add_f32_dpp v160, v161, v161 row_half_mirror row_mask:0xf bank_mask:0xa
    v_add_f32_dpp v162, v163, v163 row_half_mirror row_mask:0xf bank_mask:0xa
    s_nop 0
    v_add_f32_dpp v160, v160, v160 quad_perm:[2,3,0,1] row_mask:0xf bank_mask:0xf
    v_add_f32_dpp v162, v162, v162 quad_perm:[2,3,0,1] row_mask:0xf bank_mask:0xf
    v_cndmask_b32 v160, v160, v162, s[40:41]
    s_nop 1
    v_add_f32_dpp v160, v160, v160 quad_perm:[1,0,3,2] row_mask:0xf bank_mask:0xf
    v_cvt_pk_bf16_f32 v140, v160, v160
    s_nop 1
    v_and_b32_dpp v148, v140, v136 row_newbcast:0 row_mask:0xf bank_mask:0xf
    v_and_b32_dpp v149, v140, v137 row_newbcast:0 row_mask:0xf bank_mask:0xf
    v_and_b32_dpp v150, v140, v138 row_newbcast:0 row_mask:0xf bank_mask:0xf
    v_and_b32_dpp v151, v140, v139 row_newbcast:0 row_mask:0xf bank_mask:0xf
    v_and_b32_dpp v152, v140, v136 row_newbcast:2 row_mask:0xf bank_mask:0xf
    v_and_b32_dpp v153, v140, v137 row_newbcast:2 row_mask:0xf bank_mask:0xf
    v_and_b32_dpp v154, v140, v138 row_newbcast:2 row_mask:0xf bank_mask:0xf
    v_and_b32_dpp v155, v140, v139 row_newbcast:2 row_mask:0xf bank_mask:0xf
    v_mfma_f32_16x16x32_bf16 v[144:147], v[148:151], v[8:11], 0
    v_and_b32_dpp v148, v140, v136 row_newbcast:4 row_mask:0xf bank_mask:0xf
    v_and_b32_dpp v149, v140, v137 row_newbcast:4 row_mask:0xf bank_mask:0xf
    v_and_b32_dpp v150, v140, v138 row_newbcast:4 row_mask:0xf bank_mask:0xf
    v_and_b32_dpp v151, v140, v139 row_newbcast:4 row_mask:0xf bank_mask:0xf
    v_mfma_f32_16x16x32_bf16 v[144:147], v[152:155], v[12:15], v[144:147]
    v_and_b32_dpp v152, v140, v136 row_newbcast:6 row_mask:0xf bank_mask:0xf
    v_and_b32_dpp v153, v140, v137 row_newbcast:6 row_mask:0xf bank_mask:0xf
    v_and_b32_dpp v154, v140, v138 row_newbcast:6 row_mask:0xf bank_mask:0xf
    v_and_b32_dpp v155, v140, v139 row_newbcast:6 row_mask:0xf bank_mask:0xf
    v_mfma_f32_16x16x32_bf16 v[144:147], v[148:151], v[16:19], v[144:147]
    v_and_b32_dpp v148, v140, v136 row_newbcast:8 row_mask:0xf bank_mask:0xf
    v_and_b32_dpp v149, v140, v137 row_newbcast:8 row_mask:0xf bank_mask:0xf
    v_and_b32_dpp v150, v140, v138 row_newbcast:8 row_mask:0xf bank_mask:0xf
    v_and_b32_dpp v151, v140, v139 row_newbcast:8 row_mask:0xf bank_mask:0xf
    v_mfma_f32_16x16x32_bf16 v[144:147], v[152:155], v[20:23], v[144:147]
    v_and_b32_dpp v152, v140, v136 row_newbcast:10 row_mask:0xf bank_mask:0xf
    v_and_b32_dpp v153, v140, v137 row_newbcast:10 row_mask:0xf bank_mask:0xf
    v_and_b32_dpp v154, v140, v138 row_newbcast:10 row_mask:0xf bank_mask:0xf
    v_and_b32_dpp v155, v140, v139 row_newbcast:10 row_mask:0xf bank_mask:0xf
    v_mfma_f32_16x16x32_bf16 v[144:147], v[148:151], v[24:27], v[144:147]
    v_and_b32_dpp v148, v140, v136 row_newbcast:12 row_mask:0xf bank_mask:0xf
    v_and_b32_dpp v149, v140, v137 row_newbcast:12 row_mask:0xf bank_mask:0xf
    v_and_b32_dpp v150, v140, v138 row_newbcast:12 row_mask:0xf bank_mask:0xf
    v_and_b32_dpp v151, v140, v139 row_newbcast:12 row_mask:0xf bank_mask:0xf
    v_mfma_f32_16x16x32_bf16 v[144:147], v[152:155], v[28:31], v[144:147]
    v_and_b32_dpp v152, v140, v136 row_newbcast:14 row_mask:0xf bank_mask:0xf
    v_and_b32_dpp v153, v140, v137 row_newbcast:14 row_mask:0xf bank_mask:0xf
    v_and_b32_dpp v154, v140, v138 row_newbcast:14 row_mask:0xf bank_mask:0xf
    v_and_b32_dpp v155, v140, v139 row_newbcast:14 row_mask:0xf bank_mask:0xf
    v_mfma_f32_16x16x32_bf16 v[144:147], v[148:151], v[32:35], v[144:147]
    s_nop 0
    v_mfma_f32_16x16x32_bf16 v[144:147], v[152:155], v[36:39], v[144:147]
    s_mov_b32 exec_hi, s61
    s_nop 6
    ds_write_b128 v5, v[144:147] offset:8192
    s_mov_b64 exec, 1
    ds_add_rtn_u32 v6, v2, v6 offset:164
    s_mov_b64 exec, -1
    ds_read_b128 v[156:159], v43 offset:8192
    ds_read_b128 v[160:163], v43 offset:9216
    ds_read_b128 v[164:167], v43 offset:10240
    ds_read_b128 v[148:151], v43 offset:11264
    s_waitcnt lgkmcnt(0)
    v_readfirstlane_b32 s46, v6
    v_pk_add_f32 v[156:157], v[156:157], v[160:161]
    v_pk_add_f32 v[158:159], v[158:159], v[162:163]
    v_pk_add_f32 v[164:165], v[164:165], v[148:149]
    v_pk_add_f32 v[166:167], v[166:167], v[150:151]
    s_cmp_eq_u32 s46, 3
    s_cbranch_scc0 L_end
    v_pk_add_f32 v[156:157], v[156:157], v[164:165]
    v_pk_add_f32 v[158:159], v[158:159], v[166:167]
    v_bfi_b32 v156, s58, v143, v156
    v_bfi_b32 v157, s58, v143, v157
    v_bfi_b32 v158, s58, v143, v158
    v_bfi_b32 v159, s58, v143, v159
    s_mov_b32 exec_hi, 0xff
    global_store_dwordx4 v7, v[156:159], s[26:27] sc1
    s_branch L_end
L_aux:
    s_setprio 3
    v_mov_b32 v2, 0
    v_and_b32 v3, 15, v0
    s_mov_b32 s38, 1048576
    s_lshl_b32 s30, s28, 3
    s_add_u32 s30, s30, s29
    s_cmp_ge_u32 s3, 2
    s_cbranch_scc1 L_cd
    s_cmp_eq_u32 s3, 1
    s_cselect_b32 s46, 27, 64
    s_cmp_ge_u32 s28, s46
    s_cbranch_scc1 L_cd1
    v_lshrrev_b32 v1, 4, v0
    v_mul_u32_u24 v4, 20, v0
    s_lshl_b32 s46, s29, 2
    v_add_u32 v5, s46, v1
    v_lshlrev_b32 v7, 1, v5
    v_lshl_add_u32 v6, v3, 6, v7
    v_and_b32 v7, 0xff, v6
    s_waitcnt lgkmcnt(0)
    s_load_dword s56, s[26:27], 397312
    global_load_dwordx4 v[88:91], v4, s[4:5]
    global_load_dword v92, v4, s[4:5] offset:16
    global_load_ushort v93, v6, s[4:5]
    global_load_ushort v94, v7, s[4:5] offset:1024
    s_add_u32 s48, s10, 128
    s_addc_u32 s49, s11, 0
    s_cmp_eq_u32 s3, 0
    s_cselect_b32 s50, s10, s16
    s_cselect_b32 s51, s11, s17
    s_cselect_b32 s48, s48, s18
    s_cselect_b32 s49, s49, s19
    s_movk_i32 s44, 3456
    s_cselect_b32 s44, 8192, s44
    s_mov_b32 s45, 0
    s_cselect_b32 s46, 8, 7
    s_lshl_b32 s46, s28, s46
    v_mul_lo_u32 v6, v5, s44
    v_and_b32 v7, 7, v3
    v_lshl_add_u32 v6, v7, 4, v6
    v_add_u32 v6, s46, v6
    v_mov_b32 v7, 0
    v_cmp_gt_u32 vcc, 8, v3
    v_mov_b32 v4, s48
    v_mov_b32 v5, s49
    v_mov_b32 v95, s50
    v_mov_b32 v96, s51
    v_cndmask_b32 v4, v4, v95, vcc
    v_cndmask_b32 v5, v5, v96, vcc
    v_lshl_add_u64 v[4:5], v[6:7], 0, v[4:5]
    s_lshl_b32 s44, s44, 5
    global_load_dwordx4 v[8:11], v[4:5], off nt
    v_lshl_add_u64 v[4:5], v[4:5], 0, s[44:45]
    global_load_dwordx4 v[12:15], v[4:5], off nt
    v_lshl_add_u64 v[4:5], v[4:5], 0, s[44:45]
    global_load_dwordx4 v[16:19], v[4:5], off nt
    v_lshl_add_u64 v[4:5], v[4:5], 0, s[44:45]
    global_load_dwordx4 v[20:23], v[4:5], off nt
    v_lshl_add_u64 v[4:5], v[4:5], 0, s[44:45]
    global_load_dwordx4 v[24:27], v[4:5], off nt
    v_lshl_add_u64 v[4:5], v[4:5], 0, s[44:45]
    global_load_dwordx4 v[28:31], v[4:5], off nt
    v_lshl_add_u64 v[4:5], v[4:5], 0, s[44:45]
    global_load_dwordx4 v[32:35], v[4:5], off nt
    v_lshl_add_u64 v[4:5], v[4:5], 0, s[44:45]
    global_load_dwordx4 v[36:39], v[4:5], off nt
    v_lshl_add_u64 v[4:5], v[4:5], 0, s[44:45]
    global_load_dwordx4 v[40:43], v[4:5], off nt
    v_lshl_add_u64 v[4:5], v[4:5], 0, s[44:45]
    global_load_dwordx4 v[44:47], v[4:5], off nt
    v_lshl_add_u64 v[4:5], v[4:5], 0, s[44:45]
    global_load_dwordx4 v[48:51], v[4:5], off nt
    v_lshl_add_u64 v[4:5], v[4:5], 0, s[44:45]
    global_load_dwordx4 v[52:55], v[4:5], off nt
    v_lshl_add_u64 v[4:5], v[4:5], 0, s[44:45]
    global_load_dwordx4 v[56:59], v[4:5], off nt
    v_lshl_add_u64 v[4:5], v[4:5], 0, s[44:45]
    global_load_dwordx4 v[60:63], v[4:5], off nt
    v_lshl_add_u64 v[4:5], v[4:5], 0, s[44:45]
    global_load_dwordx4 v[64:67], v[4:5], off nt
    v_lshl_add_u64 v[4:5], v[4:5], 0, s[44:45]
    global_load_dwordx4 v[68:71], v[4:5], off nt
    v_lshl_add_u64 v[4:5], v[4:5], 0, s[44:45]
    global_load_dwordx4 v[72:75], v[4:5], off nt
    v_lshl_add_u64 v[4:5], v[4:5], 0, s[44:45]
    global_load_dwordx4 v[76:79], v[4:5], off nt
    v_lshl_add_u64 v[4:5], v[4:5], 0, s[44:45]
    global_load_dwordx4 v[80:83], v[4:5], off nt
    v_lshl_add_u64 v[4:5], v[4:5], 0, s[44:45]
    global_load_dwordx4 v[84:87], v[4:5], off nt
    s_waitcnt lgkmcnt(0)
    s_barrier
    v_and_b32 v156, 1, v3
    v_lshlrev_b32 v156, 4, v156
    v_mov_b32 v157, 0xffff
    v_lshlrev_b32 v157, v156, v157
    v_lshrrev_b32 v156, 1, v3
    v_cmp_eq_u32 s[48:49], 0, v156
    v_cmp_eq_u32 s[50:51], 1, v156
    v_cmp_eq_u32 s[52:53], 2, v156
    v_cmp_eq_u32 s[54:55], 3, v156
    v_cndmask_b32 v136, 0, v157, s[48:49]
    v_cndmask_b32 v137, 0, v157, s[50:51]
    v_cndmask_b32 v138, 0, v157, s[52:53]
    v_cndmask_b32 v139, 0, v157, s[54:55]
    s_add_u32 s57, s56, 1
    s_movk_i32 s58, 63
    s_movk_i32 s59, 65472
    v_mov_b32 v143, s57
    s_getreg_b32 s46, hwreg(HW_REG_XCC_ID, 0, 4)
    v_xor_b32 v142, s46, v143
    s_waitcnt vmcnt(20)
    v_lshlrev_b32 v100, 16, v88
    v_and_b32 v101, 0xffff0000, v88
    v_lshlrev_b32 v102, 16, v89
    v_and_b32 v103, 0xffff0000, v89
    v_lshlrev_b32 v104, 16, v90
    v_and_b32 v105, 0xffff0000, v90
    v_lshlrev_b32 v106, 16, v91
    v_and_b32 v107, 0xffff0000, v91
    v_lshlrev_b32 v108, 16, v92
    v_and_b32 v109, 0xffff0000, v92
    v_add_f32 v110, v100, v101
    v_add_f32 v110, v110, v102
    v_add_f32 v110, v110, v103
    v_add_f32 v110, v110, v104
    v_add_f32 v110, v110, v105
    v_add_f32 v110, v110, v106
    v_add_f32 v110, v110, v107
    v_add_f32 v110, v110, v108
    v_add_f32 v110, v110, v109
    s_nop 1
    v_add_f32_dpp v110, v110, v110 row_ror:8 row_mask:0xf bank_mask:0xf
    s_nop 1
    v_add_f32_dpp v110, v110, v110 row_ror:4 row_mask:0xf bank_mask:0xf
    s_nop 1
    v_add_f32_dpp v110, v110, v110 row_ror:2 row_mask:0xf bank_mask:0xf
    s_nop 1
    v_add_f32_dpp v110, v110, v110 row_ror:1 row_mask:0xf bank_mask:0xf
    s_nop 1
    v_add_f32_dpp v110, v110, v110 row_bcast:15 row_mask:0xa bank_mask:0xf
    s_nop 1
    v_add_f32_dpp v110, v110, v110 row_bcast:31 row_mask:0xc bank_mask:0xf
    s_nop 0
    v_readlane_b32 s46, v110, 63
    v_mov_b32 v111, 0x3acccccd
    s_nop 0
    v_mul_f32 v112, s46, v111
    v_sub_f32 v100, v100, v112
    v_sub_f32 v101, v101, v112
    v_sub_f32 v102, v102, v112
    v_sub_f32 v103, v103, v112
    v_sub_f32 v104, v104, v112
    v_sub_f32 v105, v105, v112
    v_sub_f32 v106, v106, v112
    v_sub_f32 v107, v107, v112
    v_sub_f32 v108, v108, v112
    v_sub_f32 v109, v109, v112
    v_mul_f32 v110, v100, v100
    v_fmac_f32 v110, v101, v101
    v_fmac_f32 v110, v102, v102
    v_fmac_f32 v110, v103, v103
    v_fmac_f32 v110, v104, v104
    v_fmac_f32 v110, v105, v105
    v_fmac_f32 v110, v106, v106
    v_fmac_f32 v110, v107, v107
    v_fmac_f32 v110, v108, v108
    v_fmac_f32 v110, v109, v109
    s_nop 1
    v_add_f32_dpp v110, v110, v110 row_ror:8 row_mask:0xf bank_mask:0xf
    s_nop 1
    v_add_f32_dpp v110, v110, v110 row_ror:4 row_mask:0xf bank_mask:0xf
    s_nop 1
    v_add_f32_dpp v110, v110, v110 row_ror:2 row_mask:0xf bank_mask:0xf
    s_nop 1
    v_add_f32_dpp v110, v110, v110 row_ror:1 row_mask:0xf bank_mask:0xf
    s_nop 1
    v_add_f32_dpp v110, v110, v110 row_bcast:15 row_mask:0xa bank_mask:0xf
    s_nop 1
    v_add_f32_dpp v110, v110, v110 row_bcast:31 row_mask:0xc bank_mask:0xf
    s_nop 0
    v_readlane_b32 s46, v110, 63
    s_nop 1
    v_mul_f32 v113, s46, v111
    v_cvt_pk_bf16_f32 v112, v112, v112
    v_and_b32 v112, 0xffff0000, v112
    v_cvt_pk_bf16_f32 v113, v113, v113
    v_and_b32 v113, 0xffff0000, v113
    v_add_f32 v113, 0x3727c5ac, v113
    v_cvt_pk_bf16_f32 v113, v113, v113
    v_and_b32 v113, 0xffff0000, v113
    v_sqrt_f32 v113, v113
    s_nop 0
    v_cvt_pk_bf16_f32 v113, v113, v113
    v_and_b32 v113, 0xffff0000, v113
    v_rcp_f32 v114, v113
    v_lshlrev_b32 v93, 16, v93
    v_sub_f32 v93, v93, v112
    v_cvt_pk_bf16_f32 v93, v93, v93
    v_and_b32 v93, 0xffff0000, v93
    v_mul_f32 v115, v93, v114
    v_fma_f32 v116, -v115, v113, v93
    v_fmac_f32 v115, v116, v114
    v_cvt_pk_bf16_f32 v140, v115, v115
    v_lshlrev_b32 v94, 16, v94
    v_sub_f32 v94, v94, v112
    v_cvt_pk_bf16_f32 v94, v94, v94
    v_and_b32 v94, 0xffff0000, v94
    v_mul_f32 v115, v94, v114
    v_fma_f32 v116, -v115, v113, v94
    v_fmac_f32 v115, v116, v114
    v_cvt_pk_bf16_f32 v141, v115, v115
    s_lshl_b32 s39, s3, 17
    s_lshl_b32 s46, s30, 9
    s_add_u32 s46, s46, s39
    v_lshl_add_u32 v4, v0, 4, s46
    s_lshl_b32 s46, s28, 12
    s_add_u32 s46, s46, s39
    v_lshl_add_u32 v5, v0, 4, s46
    v_and_b32_dpp v148, v140, v136 row_newbcast:0 row_mask:0xf bank_mask:0xf
    v_and_b32_dpp v149, v140, v137 row_newbcast:0 row_mask:0xf bank_mask:0xf
    v_and_b32_dpp v150, v140, v138 row_newbcast:0 row_mask:0xf bank_mask:0xf
    v_and_b32_dpp v151, v140, v139 row_newbcast:0 row_mask:0xf bank_mask:0xf
    v_and_b32_dpp v152, v140, v136 row_newbcast:1 row_mask:0xf bank_mask:0xf
    v_and_b32_dpp v153, v140, v137 row_newbcast:1 row_mask:0xf bank_mask:0xf
    v_and_b32_dpp v154, v140, v138 row_newbcast:1 row_mask:0xf bank_mask:0xf
    v_and_b32_dpp v155, v140, v139 row_newbcast:1 row_mask:0xf bank_mask:0xf
    s_waitcnt vmcnt(19)
    v_mfma_f32_16x16x32_bf16 v[144:147], v[148:151], v[8:11], 0
    v_and_b32_dpp v148, v140, v136 row_newbcast:2 row_mask:0xf bank_mask:0xf
    v_and_b32_dpp v149, v140, v137 row_newbcast:2 row_mask:0xf bank_mask:0xf
    v_and_b32_dpp v150, v140, v138 row_newbcast:2 row_mask:0xf bank_mask:0xf
    v_and_b32_dpp v151, v140, v139 row_newbcast:2 row_mask:0xf bank_mask:0xf
    s_waitcnt vmcnt(18)
    v_mfma_f32_16x16x32_bf16 v[144:147], v[152:155], v[12:15], v[144:147]
    v_and_b32_dpp v152, v140, v136 row_newbcast:3 row_mask:0xf bank_mask:0xf
    v_and_b32_dpp v153, v140, v137 row_newbcast:3 row_mask:0xf bank_mask:0xf
    v_and_b32_dpp v154, v140, v138 row_newbcast:3 row_mask:0xf bank_mask:0xf
    v_and_b32_dpp v155, v140, v139 row_newbcast:3 row_mask:0xf bank_mask:0xf
    s_waitcnt vmcnt(17)
    v_mfma_f32_16x16x32_bf16 v[144:147], v[148:151], v[16:19], v[144:147]
    v_and_b32_dpp v148, v140, v136 row_newbcast:4 row_mask:0xf bank_mask:0xf
    v_and_b32_dpp v149, v140, v137 row_newbcast:4 row_mask:0xf bank_mask:0xf
    v_and_b32_dpp v150, v140, v138 row_newbcast:4 row_mask:0xf bank_mask:0xf
    v_and_b32_dpp v151, v140, v139 row_newbcast:4 row_mask:0xf bank_mask:0xf
    s_waitcnt vmcnt(16)
    v_mfma_f32_16x16x32_bf16 v[144:147], v[152:155], v[20:23], v[144:147]
    v_and_b32_dpp v152, v140, v136 row_newbcast:5 row_mask:0xf bank_mask:0xf
    v_and_b32_dpp v153, v140, v137 row_newbcast:5 row_mask:0xf bank_mask:0xf
    v_and_b32_dpp v154, v140, v138 row_newbcast:5 row_mask:0xf bank_mask:0xf
    v_and_b32_dpp v155, v140, v139 row_newbcast:5 row_mask:0xf bank_mask:0xf
    s_waitcnt vmcnt(15)
    v_mfma_f32_16x16x32_bf16 v[144:147], v[148:151], v[24:27], v[144:147]
    v_and_b32_dpp v148, v140, v136 row_newbcast:6 row_mask:0xf bank_mask:0xf
    v_and_b32_dpp v149, v140, v137 row_newbcast:6 row_mask:0xf bank_mask:0xf
    v_and_b32_dpp v150, v140, v138 row_newbcast:6 row_mask:0xf bank_mask:0xf
    v_and_b32_dpp v151, v140, v139 row_newbcast:6 row_mask:0xf bank_mask:0xf
    s_waitcnt vmcnt(14)
    v_mfma_f32_16x16x32_bf16 v[144:147], v[152:155], v[28:31], v[144:147]
    v_and_b32_dpp v152, v140, v136 row_newbcast:7 row_mask:0xf bank_mask:0xf
    v_and_b32_dpp v153, v140, v137 row_newbcast:7 row_mask:0xf bank_mask:0xf
    v_and_b32_dpp v154, v140, v138 row_newbcast:7 row_mask:0xf bank_mask:0xf
    v_and_b32_dpp v155, v140, v139 row_newbcast:7 row_mask:0xf bank_mask:0xf
    s_waitcnt vmcnt(13)
    v_mfma_f32_16x16x32_bf16 v[144:147], v[148:151], v[32:35], v[144:147]
    v_and_b32_dpp v148, v140, v136 row_newbcast:8 row_mask:0xf bank_mask:0xf
    v_and_b32_dpp v149, v140, v137 row_newbcast:8 row_mask:0xf bank_mask:0xf
    v_and_b32_dpp v150, v140, v138 row_newbcast:8 row_mask:0xf bank_mask:0xf
    v_and_b32_dpp v151, v140, v139 row_newbcast:8 row_mask:0xf bank_mask:0xf
    s_waitcnt vmcnt(12)
    v_mfma_f32_16x16x32_bf16 v[144:147], v[152:155], v[36:39], v[144:147]
    v_and_b32_dpp v152, v140, v136 row_newbcast:9 row_mask:0xf bank_mask:0xf
    v_and_b32_dpp v153, v140, v137 row_newbcast:9 row_mask:0xf bank_mask:0xf
    v_and_b32_dpp v154, v140, v138 row_newbcast:9 row_mask:0xf bank_mask:0xf
    v_and_b32_dpp v155, v140, v139 row_newbcast:9 row_mask:0xf bank_mask:0xf
    s_waitcnt vmcnt(11)
    v_mfma_f32_16x16x32_bf16 v[144:147], v[148:151], v[40:43], v[144:147]
    v_and_b32_dpp v148, v140, v136 row_newbcast:10 row_mask:0xf bank_mask:0xf
    v_and_b32_dpp v149, v140, v137 row_newbcast:10 row_mask:0xf bank_mask:0xf
    v_and_b32_dpp v150, v140, v138 row_newbcast:10 row_mask:0xf bank_mask:0xf
    v_and_b32_dpp v151, v140, v139 row_newbcast:10 row_mask:0xf bank_mask:0xf
    s_waitcnt vmcnt(10)
    v_mfma_f32_16x16x32_bf16 v[144:147], v[152:155], v[44:47], v[144:147]
    v_and_b32_dpp v152, v140, v136 row_newbcast:11 row_mask:0xf bank_mask:0xf
    v_and_b32_dpp v153, v140, v137 row_newbcast:11 row_mask:0xf bank_mask:0xf
    v_and_b32_dpp v154, v140, v138 row_newbcast:11 row_mask:0xf bank_mask:0xf
    v_and_b32_dpp v155, v140, v139 row_newbcast:11 row_mask:0xf bank_mask:0xf
    s_waitcnt vmcnt(9)
    v_mfma_f32_16x16x32_bf16 v[144:147], v[148:151], v[48:51], v[144:147]
    v_and_b32_dpp v148, v140, v136 row_newbcast:12 row_mask:0xf bank_mask:0xf
    v_and_b32_dpp v149, v140, v137 row_newbcast:12 row_mask:0xf bank_mask:0xf
    v_and_b32_dpp v150, v140, v138 row_newbcast:12 row_mask:0xf bank_mask:0xf
    v_and_b32_dpp v151, v140, v139 row_newbcast:12 row_mask:0xf bank_mask:0xf
    s_waitcnt vmcnt(8)
    v_mfma_f32_16x16x32_bf16 v[144:147], v[152:155], v[52:55], v[144:147]
    v_and_b32_dpp v152, v140, v136 row_newbcast:13 row_mask:0xf bank_mask:0xf
    v_and_b32_dpp v153, v140, v137 row_newbcast:13 row_mask:0xf bank_mask:0xf
    v_and_b32_dpp v154, v140, v138 row_newbcast:13 row_mask:0xf bank_mask:0xf
    v_and_b32_dpp v155, v140, v139 row_newbcast:13 row_mask:0xf bank_mask:0xf
    s_waitcnt vmcnt(7)
    v_mfma_f32_16x16x32_bf16 v[144:147], v[148:151], v[56:59], v[144:147]
    v_and_b32_dpp v148, v140, v136 row_newbcast:14 row_mask:0xf bank_mask:0xf
    v_and_b32_dpp v149, v140, v137 row_newbcast:14 row_mask:0xf bank_mask:0xf
    v_and_b32_dpp v150, v140, v138 row_newbcast:14 row_mask:0xf bank_mask:0xf
    v_and_b32_dpp v151, v140, v139 row_newbcast:14 row_mask:0xf bank_mask:0xf
    s_waitcnt vmcnt(6)
    v_mfma_f32_16x16x32_bf16 v[144:147], v[152:155], v[60:63], v[144:147]
    v_and_b32_dpp v152, v140, v136 row_newbcast:15 row_mask:0xf bank_mask:0xf
    v_and_b32_dpp v153, v140, v137 row_newbcast:15 row_mask:0xf bank_mask:0xf
    v_and_b32_dpp v154, v140, v138 row_newbcast:15 row_mask:0xf bank_mask:0xf
    v_and_b32_dpp v155, v140, v139 row_newbcast:15 row_mask:0xf bank_mask:0xf
    s_waitcnt vmcnt(5)
    v_mfma_f32_16x16x32_bf16 v[144:147], v[148:151], v[64:67], v[144:147]
    v_and_b32_dpp v148, v141, v136 row_newbcast:0 row_mask:0xf bank_mask:0xf
    v_and_b32_dpp v149, v141, v137 row_newbcast:0 row_mask:0xf bank_mask:0xf
    v_and_b32_dpp v150, v141, v138 row_newbcast:0 row_mask:0xf bank_mask:0xf
    v_and_b32_dpp v151, v141, v139 row_newbcast:0 row_mask:0xf bank_mask:0xf
    s_waitcnt vmcnt(4)
    v_mfma_f32_16x16x32_bf16 v[144:147], v[152:155], v[68:71], v[144:147]
    v_and_b32_dpp v152, v141, v136 row_newbcast:1 row_mask:0xf bank_mask:0xf
    v_and_b32_dpp v153, v141, v137 row_newbcast:1 row_mask:0xf bank_mask:0xf
    v_and_b32_dpp v154, v141, v138 row_newbcast:1 row_mask:0xf bank_mask:0xf
    v_and_b32_dpp v155, v141, v139 row_newbcast:1 row_mask:0xf bank_mask:0xf
    s_waitcnt vmcnt(3)
    v_mfma_f32_16x16x32_bf16 v[144:147], v[148:151], v[72:75], v[144:147]
    v_and_b32_dpp v148, v141, v136 row_newbcast:2 row_mask:0xf bank_mask:0xf
    v_and_b32_dpp v149, v141, v137 row_newbcast:2 row_mask:0xf bank_mask:0xf
    v_and_b32_dpp v150, v141, v138 row_newbcast:2 row_mask:0xf bank_mask:0xf
    v_and_b32_dpp v151, v141, v139 row_newbcast:2 row_mask:0xf bank_mask:0xf
    s_waitcnt vmcnt(2)
    v_mfma_f32_16x16x32_bf16 v[144:147], v[152:155], v[76:79], v[144:147]
    v_and_b32_dpp v152, v141, v136 row_newbcast:3 row_mask:0xf bank_mask:0xf
    v_and_b32_dpp v153, v141, v137 row_newbcast:3 row_mask:0xf bank_mask:0xf
    v_and_b32_dpp v154, v141, v138 row_newbcast:3 row_mask:0xf bank_mask:0xf
    v_and_b32_dpp v155, v141, v139 row_newbcast:3 row_mask:0xf bank_mask:0xf
    s_waitcnt vmcnt(1)
    v_mfma_f32_16x16x32_bf16 v[144:147], v[148:151], v[80:83], v[144:147]
    s_waitcnt vmcnt(0)
    v_mfma_f32_16x16x32_bf16 v[144:147], v[152:155], v[84:87], v[144:147]
    s_nop 7
    v_bfi_b32 v144, s58, v143, v144
    v_bfi_b32 v145, s58, v143, v145
    v_bfi_b32 v146, s58, v143, v146
    v_bfi_b32 v147, s58, v142, v147
    s_mov_b32 exec_hi, 0
    global_store_dwordx4 v4, v[144:147], s[26:27]
    s_mov_b64 exec, -1
    s_waitcnt vmcnt(0)
    s_mov_b32 s61, 3
    s_cmp_eq_u32 s3, 0
    s_cbranch_scc1 L_ab2
    v_mov_b32 v157, 1
    ds_write_b32 v2, v157 offset:172
L_lw26:
    ds_read_b32 v156, v2 offset:140
    s_waitcnt lgkmcnt(0)
    v_cmp_eq_u32 vcc, 0, v156
    s_cbranch_vccz L_ld27
    s_sleep 8
    s_sub_u32 s38, s38, 1
    s_cbranch_scc0 L_lw26
    s_branch L_end
L_ld27:
    v_cmp_eq_u32 vcc, 1, v156
    s_cbranch_vccnz L_end
    s_mov_b32 exec_hi, 0
    global_store_dwordx4 v4, v[144:147], s[26:27] sc1
    s_branch L_end
L_ab2:
L_ga28:
    global_load_dwordx4 v[96:99], v5, s[26:27] offset:0 sc1 nt
    global_load_dwordx4 v[100:103], v5, s[26:27] offset:1024 sc1 nt
    global_load_dwordx4 v[104:107], v5, s[26:27] offset:2048 sc1 nt
    global_load_dwordx4 v[108:111], v5, s[26:27] offset:3072 sc1 nt
    s_waitcnt vmcnt(0)
    v_bitop3_b32 v112, v96, v97, v143 bitop3:0x7e
    v_bitop3_b32 v113, v100, v101, v143 bitop3:0x7e
    v_bitop3_b32 v114, v104, v105, v143 bitop3:0x7e
    v_bitop3_b32 v115, v108, v109, v143 bitop3:0x7e
    v_bitop3_b32 v116, v98, v102, v143 bitop3:0x7e
    v_bitop3_b32 v117, v106, v110, v143 bitop3:0x7e
    v_or3_b32 v112, v112, v113, v114
    v_or3_b32 v112, v112, v115, v116
    v_or_b32 v112, v112, v117
    v_and_b32 v112, 63, v112
    v_cmp_ne_u32 vcc, 0, v112
    s_cbranch_vccz L_ge29
    s_sub_u32 s61, s61, 1
    s_cmp_eq_u32 s61, 0
    s_cbranch_scc0 L_gf30
    s_mov_b32 exec_hi, 0
    global_store_dwordx4 v4, v[144:147], s[26:27] sc1
    s_mov_b64 exec, -1
L_gf30:
    s_sleep 4
    s_sub_u32 s38, s38, 1
    s_cbranch_scc0 L_ga28
    s_branch L_end
L_ge29:
    v_bitop3_b32 v112, v99, v103, v142 bitop3:0x7e
    v_bitop3_b32 v113, v107, v111, v142 bitop3:0x7e
    v_or_b32 v112, v112, v113
    v_and_b32 v112, 63, v112
    v_cmp_ne_u32 vcc, 0, v112
    v_and_or_b32 v96, v96, s59, 32
    v_and_or_b32 v97, v97, s59, 32
    v_and_or_b32 v98, v98, s59, 32
    v_and_or_b32 v99, v99, s59, 32
    v_and_or_b32 v100, v100, s59, 32
    v_and_or_b32 v101, v101, s59, 32
    v_and_or_b32 v102, v102, s59, 32
    v_and_or_b32 v103, v103, s59, 32
    v_and_or_b32 v104, v104, s59, 32
    v_and_or_b32 v105, v105, s59, 32
    v_and_or_b32 v106, v106, s59, 32
    v_and_or_b32 v107, v107, s59, 32
    v_and_or_b32 v108, v108, s59, 32
    v_and_or_b32 v109, v109, s59, 32
    v_and_or_b32 v110, v110, s59, 32
    v_and_or_b32 v111, v111, s59, 32
    v_pk_add_f32 v[96:97], v[96:97], v[100:101]
    v_pk_add_f32 v[98:99], v[98:99], v[102:103]
    v_pk_add_f32 v[96:97], v[96:97], v[104:105]
    v_pk_add_f32 v[98:99], v[98:99], v[106:107]
    v_pk_add_f32 v[96:97], v[96:97], v[108:109]
    v_pk_add_f32 v[98:99], v[98:99], v[110:111]
    s_nop 1
    v_permlane32_swap_b32 v96, v98
    v_permlane32_swap_b32 v97, v99
    v_add_f32 v96, v96, v98
    v_add_f32 v97, v97, v99
    s_cmp_eq_u32 s3, 0
    s_cbranch_scc0 L_b
    v_cvt_pk_bf16_f32 v96, v96, v97
    v_and_b32 v6, 1, v1
    v_lshlrev_b32 v6, 3, v6
    v_lshl_add_u32 v6, v3, 4, v6
    v_lshrrev_b32 v7, 1, v1
    v_lshl_add_u32 v6, v7, 2, v6
    s_cmp_eq_u64 vcc, 0
    s_cselect_b32 s46, 1, 2
    v_mov_b32 v98, 1
    v_mov_b32 v99, s46
    ds_write_b32 v6, v96 offset:256
    ds_write_b64 v2, v[98:99] offset:136
    s_cbranch_scc1 L_fin
    s_mov_b32 exec_hi, 0
    global_store_dwordx4 v4, v[144:147], s[26:27] sc1
    s_branch L_fin
L_b:
    v_mov_b32_dpp v98, v96 row_ror:8 row_mask:0xf bank_mask:0xf
    v_mov_b32_dpp v96, v97 row_ror:8 row_mask:0xf bank_mask:0xc
    s_nop 0
    v_mov_b32_dpp v97, v98 quad_perm:[0,1,2,3] row_mask:0xf bank_mask:0x3
    v_cvt_pk_bf16_f32 v96, v96, v96
    v_and_b32 v96, 0xffff0000, v96
    v_cvt_pk_bf16_f32 v97, v97, v97
    v_and_b32 v97, 0xffff0000, v97
    v_mul_f32 v98, 0xbfb8aa3b, v96
    v_exp_f32 v98, v98
    s_nop 0
    v_add_f32 v98, 1.0, v98
    v_rcp_f32 v98, v98
    s_nop 0
    v_mul_f32 v96, v96, v98
    v_cvt_pk_bf16_f32 v96, v96, v96
    v_and_b32 v96, 0xffff0000, v96
    v_mul_f32 v96, v96, v97
    v_cvt_pk_bf16_f32 v140, v96, v96
    s_nop 1
    v_and_b32_dpp v148, v140, v136 row_newbcast:0 row_mask:0xf bank_mask:0xf
    v_and_b32_dpp v149, v140, v137 row_newbcast:0 row_mask:0xf bank_mask:0xf
    v_and_b32_dpp v150, v140, v138 row_newbcast:0 row_mask:0xf bank_mask:0xf
    v_and_b32_dpp v151, v140, v139 row_newbcast:0 row_mask:0xf bank_mask:0xf
    v_and_b32_dpp v152, v140, v136 row_newbcast:1 row_mask:0xf bank_mask:0xf
    v_and_b32_dpp v153, v140, v137 row_newbcast:1 row_mask:0xf bank_mask:0xf
    v_and_b32_dpp v154, v140, v138 row_newbcast:1 row_mask:0xf bank_mask:0xf
    v_and_b32_dpp v155, v140, v139 row_newbcast:1 row_mask:0xf bank_mask:0xf
    v_mfma_f32_16x16x32_bf16 v[144:147], v[148:151], v[8:11], 0
    v_and_b32_dpp v148, v140, v136 row_newbcast:2 row_mask:0xf bank_mask:0xf
    v_and_b32_dpp v149, v140, v137 row_newbcast:2 row_mask:0xf bank_mask:0xf
    v_and_b32_dpp v150, v140, v138 row_newbcast:2 row_mask:0xf bank_mask:0xf
    v_and_b32_dpp v151, v140, v139 row_newbcast:2 row_mask:0xf bank_mask:0xf
    v_mfma_f32_16x16x32_bf16 v[144:147], v[152:155], v[12:15], v[144:147]
    v_and_b32_dpp v152, v140, v136 row_newbcast:3 row_mask:0xf bank_mask:0xf
    v_and_b32_dpp v153, v140, v137 row_newbcast:3 row_mask:0xf bank_mask:0xf
    v_and_b32_dpp v154, v140, v138 row_newbcast:3 row_mask:0xf bank_mask:0xf
    v_and_b32_dpp v155, v140, v139 row_newbcast:3 row_mask:0xf bank_mask:0xf
    v_mfma_f32_16x16x32_bf16 v[144:147], v[148:151], v[16:19], v[144:147]
    v_and_b32_dpp v148, v140, v136 row_newbcast:4 row_mask:0xf bank_mask:0xf
    v_and_b32_dpp v149, v140, v137 row_newbcast:4 row_mask:0xf bank_mask:0xf
    v_and_b32_dpp v150, v140, v138 row_newbcast:4 row_mask:0xf bank_mask:0xf
    v_and_b32_dpp v151, v140, v139 row_newbcast:4 row_mask:0xf bank_mask:0xf
    v_mfma_f32_16x16x32_bf16 v[144:147], v[152:155], v[20:23], v[144:147]
    v_and_b32_dpp v152, v140, v136 row_newbcast:5 row_mask:0xf bank_mask:0xf
    v_and_b32_dpp v153, v140, v137 row_newbcast:5 row_mask:0xf bank_mask:0xf
    v_and_b32_dpp v154, v140, v138 row_newbcast:5 row_mask:0xf bank_mask:0xf
    v_and_b32_dpp v155, v140, v139 row_newbcast:5 row_mask:0xf bank_mask:0xf
    v_mfma_f32_16x16x32_bf16 v[144:147], v[148:151], v[24:27], v[144:147]
    v_and_b32_dpp v148, v140, v136 row_newbcast:6 row_mask:0xf bank_mask:0xf
    v_and_b32_dpp v149, v140, v137 row_newbcast:6 row_mask:0xf bank_mask:0xf
    v_and_b32_dpp v150, v140, v138 row_newbcast:6 row_mask:0xf bank_mask:0xf
    v_and_b32_dpp v151, v140, v139 row_newbcast:6 row_mask:0xf bank_mask:0xf
    v_mfma_f32_16x16x32_bf16 v[144:147], v[152:155], v[28:31], v[144:147]
    v_and_b32_dpp v152, v140, v136 row_newbcast:7 row_mask:0xf bank_mask:0xf
    v_and_b32_dpp v153, v140, v137 row_newbcast:7 row_mask:0xf bank_mask:0xf
    v_and_b32_dpp v154, v140, v138 row_newbcast:7 row_mask:0xf bank_mask:0xf
    v_and_b32_dpp v155, v140, v139 row_newbcast:7 row_mask:0xf bank_mask:0xf
    v_mfma_f32_16x16x32_bf16 v[144:147], v[148:151], v[32:35], v[144:147]
    v_and_b32_dpp v148, v140, v136 row_newbcast:8 row_mask:0xf bank_mask:0xf
    v_and_b32_dpp v149, v140, v137 row_newbcast:8 row_mask:0xf bank_mask:0xf
    v_and_b32_dpp v150, v140, v138 row_newbcast:8 row_mask:0xf bank_mask:0xf
    v_and_b32_dpp v151, v140, v139 row_newbcast:8 row_mask:0xf bank_mask:0xf
    v_mfma_f32_16x16x32_bf16 v[144:147], v[152:155], v[36:39], v[144:147]
    v_and_b32_dpp v152, v140, v136 row_newbcast:9 row_mask:0xf bank_mask:0xf
    v_and_b32_dpp v153, v140, v137 row_newbcast:9 row_mask:0xf bank_mask:0xf
    v_and_b32_dpp v154, v140, v138 row_newbcast:9 row_mask:0xf bank_mask:0xf
    v_and_b32_dpp v155, v140, v139 row_newbcast:9 row_mask:0xf bank_mask:0xf
    v_mfma_f32_16x16x32_bf16 v[144:147], v[148:151], v[40:43], v[144:147]
    v_and_b32_dpp v148, v140, v136 row_newbcast:10 row_mask:0xf bank_mask:0xf
    v_and_b32_dpp v149, v140, v137 row_newbcast:10 row_mask:0xf bank_mask:0xf
    v_and_b32_dpp v150, v140, v138 row_newbcast:10 row_mask:0xf bank_mask:0xf
    v_and_b32_dpp v151, v140, v139 row_newbcast:10 row_mask:0xf bank_mask:0xf
    v_mfma_f32_16x16x32_bf16 v[144:147], v[152:155], v[44:47], v[144:147]
    v_and_b32_dpp v152, v140, v136 row_newbcast:11 row_mask:0xf bank_mask:0xf
    v_and_b32_dpp v153, v140, v137 row_newbcast:11 row_mask:0xf bank_mask:0xf
    v_and_b32_dpp v154, v140, v138 row_newbcast:11 row_mask:0xf bank_mask:0xf
    v_and_b32_dpp v155, v140, v139 row_newbcast:11 row_mask:0xf bank_mask:0xf
    v_mfma_f32_16x16x32_bf16 v[144:147], v[148:151], v[48:51], v[144:147]
    v_and_b32_dpp v148, v140, v136 row_newbcast:12 row_mask:0xf bank_mask:0xf
    v_and_b32_dpp v149, v140, v137 row_newbcast:12 row_mask:0xf bank_mask:0xf
    v_and_b32_dpp v150, v140, v138 row_newbcast:12 row_mask:0xf bank_mask:0xf
    v_and_b32_dpp v151, v140, v139 row_newbcast:12 row_mask:0xf bank_mask:0xf
    v_mfma_f32_16x16x32_bf16 v[144:147], v[152:155], v[52:55], v[144:147]
    v_and_b32_dpp v152, v140, v136 row_newbcast:13 row_mask:0xf bank_mask:0xf
    v_and_b32_dpp v153, v140, v137 row_newbcast:13 row_mask:0xf bank_mask:0xf
    v_and_b32_dpp v154, v140, v138 row_newbcast:13 row_mask:0xf bank_mask:0xf
    v_and_b32_dpp v155, v140, v139 row_newbcast:13 row_mask:0xf bank_mask:0xf
    v_mfma_f32_16x16x32_bf16 v[144:147], v[148:151], v[56:59], v[144:147]
    v_and_b32_dpp v148, v140, v136 row_newbcast:14 row_mask:0xf bank_mask:0xf
    v_and_b32_dpp v149, v140, v137 row_newbcast:14 row_mask:0xf bank_mask:0xf
    v_and_b32_dpp v150, v140, v138 row_newbcast:14 row_mask:0xf bank_mask:0xf
    v_and_b32_dpp v151, v140, v139 row_newbcast:14 row_mask:0xf bank_mask:0xf
    v_mfma_f32_16x16x32_bf16 v[144:147], v[152:155], v[60:63], v[144:147]
    v_and_b32_dpp v152, v140, v136 row_newbcast:15 row_mask:0xf bank_mask:0xf
    v_and_b32_dpp v153, v140, v137 row_newbcast:15 row_mask:0xf bank_mask:0xf
    v_and_b32_dpp v154, v140, v138 row_newbcast:15 row_mask:0xf bank_mask:0xf
    v_and_b32_dpp v155, v140, v139 row_newbcast:15 row_mask:0xf bank_mask:0xf
    v_mfma_f32_16x16x32_bf16 v[144:147], v[148:151], v[64:67], v[144:147]
    s_nop 0
    v_mfma_f32_16x16x32_bf16 v[144:147], v[152:155], v[68:71], v[144:147]
L_fpub:
    v_lshlrev_b32 v7, 4, v0
    s_mov_b32 exec_hi, 0
    s_nop 5
    ds_write_b128 v7, v[144:147] offset:8704
    v_mov_b32 v157, 1
    ds_write_b32 v2, v157 offset:176
    s_branch L_fin
L_cd:
    v_lshrrev_b32 v1, 4, v0
    s_cmp_eq_u32 s3, 2
    s_cbranch_scc0 L_d0
    s_waitcnt lgkmcnt(0)
    s_cmp_lt_u32 s28, 27
    s_cbranch_scc1 L_exit
    s_branch L_cd1
L_d0:
    v_subrev_u32 v4, 32, v0
    v_ashrrev_i32 v4, 31, v4
    v_lshlrev_b32 v5, 2, v0
    ds_write_b32 v5, v4
    s_waitcnt lgkmcnt(0)
    s_cmp_ge_u32 s28, 27
    s_cbranch_scc1 L_cd1
    s_mov_b32 s32, s20
    s_mov_b32 s33, s21
    s_mov_b32 s34, 2211840
    s_mov_b32 s35, 0x20000
    s_mul_i32 s36, s28, 81920
    s_mul_i32 s47, s29, 160
    s_add_u32 s36, s36, s47
    v_and_b32 v6, 1, v1
    v_lshlrev_b32 v6, 2, v6
    v_and_b32 v4, 2, v1
    v_add_u32 v6, v6, v4
    v_mul_u32_u24 v6, 1280, v6
    v_lshl_add_u32 v6, v3, 4, v6
    s_mov_b32 s44, 0x03ff03ff
    s_mov_b32 s45, 0x03ff03ff
    s_mov_b64 exec, s[44:45]
    buffer_load_dwordx4 v[8:11], v6, s[32:35], s36 offen nt
    buffer_load_dwordx4 v[40:43], v6, s[32:35], s36 offen offset:1280 nt
    s_add_u32 s36, s36, 10240
    buffer_load_dwordx4 v[12:15], v6, s[32:35], s36 offen nt
    buffer_load_dwordx4 v[44:47], v6, s[32:35], s36 offen offset:1280 nt
    s_add_u32 s36, s36, 10240
    buffer_load_dwordx4 v[16:19], v6, s[32:35], s36 offen nt
    buffer_load_dwordx4 v[48:51], v6, s[32:35], s36 offen offset:1280 nt
    s_add_u32 s36, s36, 10240
    buffer_load_dwordx4 v[20:23], v6, s[32:35], s36 offen nt
    buffer_load_dwordx4 v[52:55], v6, s[32:35], s36 offen offset:1280 nt
    s_add_u32 s36, s36, 10240
    buffer_load_dwordx4 v[24:27], v6, s[32:35], s36 offen nt
    buffer_load_dwordx4 v[56:59], v6, s[32:35], s36 offen offset:1280 nt
    s_add_u32 s36, s36, 10240
    buffer_load_dwordx4 v[28:31], v6, s[32:35], s36 offen nt
    buffer_load_dwordx4 v[60:63], v6, s[32:35], s36 offen offset:1280 nt
    s_add_u32 s36, s36, 10240
    buffer_load_dwordx4 v[32:35], v6, s[32:35], s36 offen nt
    buffer_load_dwordx4 v[64:67], v6, s[32:35], s36 offen offset:1280 nt
    s_add_u32 s36, s36, 10240
    buffer_load_dwordx4 v[36:39], v6, s[32:35], s36 offen nt
    buffer_load_dwordx4 v[68:71], v6, s[32:35], s36 offen offset:1280 nt
    s_mov_b64 exec, -1
L_cd1:
    s_waitcnt lgkmcnt(0)
    s_load_dword s56, s[26:27], 397312
    s_waitcnt lgkmcnt(0)
    s_barrier
    s_add_u32 s57, s56, 1
    s_movk_i32 s59, 65472
    v_mov_b32 v143, s57
    s_cmp_lt_u32 s3, 3
    s_cbranch_scc1 L_c
    v_mov_b32 v144, 0
    v_mov_b32 v145, 0
    v_mov_b32 v146, 0
    v_mov_b32 v147, 0
    s_cmp_ge_u32 s28, 27
    s_cbranch_scc1 L_fpub
    v_and_b32 v156, 1, v3
    v_lshlrev_b32 v156, 4, v156
    v_mov_b32 v157, 0xffff
    v_lshlrev_b32 v157, v156, v157
    v_lshrrev_b32 v156, 1, v3
    v_cmp_eq_u32 s[48:49], 0, v156
    v_cmp_eq_u32 s[50:51], 1, v156
    v_cmp_eq_u32 s[52:53], 2, v156
    v_cmp_eq_u32 s[54:55], 3, v156
    v_cndmask_b32 v136, 0, v157, s[48:49]
    v_cndmask_b32 v137, 0, v157, s[50:51]
    v_cndmask_b32 v138, 0, v157, s[52:53]
    v_cndmask_b32 v139, 0, v157, s[54:55]
    s_lshl_b32 s46, s28, 12
    s_add_u32 s46, s46, 131072
    v_lshl_add_u32 v5, v0, 4, s46
    v_mov_b32 v4, v5
    v_mov_b32 v142, 0
    s_mov_b32 s61, 0
L_lw31:
    ds_read_b32 v156, v2 offset:172
    s_waitcnt lgkmcnt(0)
    v_cmp_eq_u32 vcc, 0, v156
    s_cbranch_vccz L_ld32
    s_sleep 2
    s_sub_u32 s38, s38, 1
    s_cbranch_scc0 L_lw31
    s_branch L_end
L_ld32:
    s_branch L_ab2
L_fin:
    s_mov_b64 exec, -1
    s_cmp_lt_u32 s28, 27
    s_cbranch_scc1 L_end
L_c:
    s_movk_i32 s59, 64512
    v_mov_b32 v21, 512
    s_mov_b32 s40, s29
    s_sub_u32 s41, s28, 27
    s_lshl_b32 s41, s41, 2
    s_add_u32 s41, s41, s3
    v_bfe_u32 v6, v0, 2, 1
    v_bfe_u32 v7, v0, 3, 1
    v_lshl_add_u32 v6, v6, 1, v7
    s_mul_i32 s46, s40, 80
    s_lshl_b32 s48, s41, 2
    s_add_u32 s46, s46, s48
    v_add_lshl_u32 v6, v6, s46, 1
    global_load_ushort v20, v6, s[4:5]
    s_mul_i32 s46, s40, 20480
    s_lshl_b32 s47, s41, 5
    s_add_u32 s46, s46, s47
    s_add_u32 s46, s46, 524288
    v_and_b32 v22, 31, v0
    v_mul_u32_u24 v22, 640, v22
    v_lshrrev_b32 v23, 5, v0
    v_lshl_add_u32 v22, v23, 4, v22
    v_add_u32 v22, s46, v22
L_lw33:
    ds_read_b32 v156, v2 offset:164
    s_waitcnt lgkmcnt(0)
    v_cmp_gt_u32 vcc, 4, v156
    s_cbranch_vccz L_ld34
    s_sleep 4
    s_sub_u32 s38, s38, 1
    s_cbranch_scc0 L_lw33
    s_branch L_end
L_ld34:
L_pl35:
    global_load_dwordx4 v[8:11], v22, s[26:27] sc1
L_pe37:
    s_waitcnt vmcnt(0)
    v_bitop3_b32 v12, v8, v9, v143 bitop3:0x7e
    v_bitop3_b32 v13, v10, v11, v143 bitop3:0x7e
    v_or_b32 v12, v12, v13
    v_and_b32 v12, 1023, v12
    v_cmp_ne_u32 vcc, 0, v12
    s_cbranch_vccz L_pd36
    s_mov_b64 exec, vcc
    s_sub_u32 s38, s38, 1
    s_cbranch_scc0 L_pl35
    s_branch L_end
L_pd36:
    s_mov_b64 exec, -1
    v_and_or_b32 v8, v8, s59, v21
    v_and_or_b32 v9, v9, s59, v21
    v_and_or_b32 v10, v10, s59, v21
    v_and_or_b32 v11, v11, s59, v21
    v_add_f32_dpp v8, v8, v8 row_ror:8 row_mask:0xf bank_mask:0x3
    v_add_f32_dpp v10, v10, v10 row_ror:8 row_mask:0xf bank_mask:0x3
    s_nop 0
    v_add_f32_dpp v8, v9, v9 row_ror:8 row_mask:0xf bank_mask:0xc
    v_add_f32_dpp v10, v11, v11 row_ror:8 row_mask:0xf bank_mask:0xc
    v_lshlrev_b32 v20, 16, v20
    v_add_f32_dpp v8, v8, v8 row_half_mirror row_mask:0xf bank_mask:0x5
    s_nop 1
    v_add_f32_dpp v8, v10, v10 row_half_mirror row_mask:0xf bank_mask:0xa
    s_nop 1
    v_add_f32_dpp v8, v8, v8 quad_perm:[2,3,0,1] row_mask:0xf bank_mask:0xf
    s_nop 1
    v_add_f32_dpp v8, v8, v8 quad_perm:[1,0,3,2] row_mask:0xf bank_mask:0xf
    v_mov_b32 v9, v8
    s_nop 1
    v_permlane16_swap_b32 v8, v9
    v_add_f32 v8, v8, v9
    v_cvt_pk_bf16_f32 v8, v8, v8
    v_and_b32 v8, 0xffff0000, v8
    v_mov_b32 v9, v8
    s_nop 1
    v_permlane32_swap_b32 v8, v9
    v_mul_f32 v10, 0xbfb8aa3b, v9
    v_exp_f32 v10, v10
    s_nop 0
    v_add_f32 v10, 1.0, v10
    v_rcp_f32 v10, v10
    s_nop 0
    v_mul_f32 v9, v9, v10
    v_cvt_pk_bf16_f32 v9, v9, v9
    v_and_b32 v9, 0xffff0000, v9
    v_mul_f32 v8, v8, v9
    v_cvt_pk_bf16_f32 v8, v8, v8
    v_and_b32 v8, 0xffff0000, v8
    v_add_f32 v8, v8, v20
    v_cvt_pk_bf16_f32 v8, v8, v8
    s_mov_b64 exec, 0x1111
    global_store_short v6, v8, s[22:23]
    s_or_b32 s46, s40, s41
    s_cbranch_scc1 L_c9
    v_mov_b32 v9, 397312
    s_mov_b64 exec, 1
    global_store_dword v9, v143, s[26:27]
L_c9:
L_end:
L_exit:
    s_endpgm
.section .rodata,"a"
.p2align 6
.amdhsa_kernel recurrent_scan__sliding_block_cached__swiglu_ffn__decode_kernel
  .amdhsa_next_free_vgpr 168
  .amdhsa_next_free_sgpr 96
  .amdhsa_accum_offset 168
  .amdhsa_group_segment_fixed_size 0
  .amdhsa_kernarg_size 96
  .amdhsa_user_sgpr_count 2
  .amdhsa_user_sgpr_kernarg_segment_ptr 1
  .amdhsa_system_sgpr_workgroup_id_x 1
.end_amdhsa_kernel
```
